```python
import torch

def _softmax(x, axis=-1):
    return torch.softmax(x, dim=axis)
def _gelu(x):
    return torch.nn.functional.gelu(x, approximate="tanh")
def _silu(x):
    return torch.nn.functional.silu(x)
def _sigmoid(x):
    return torch.sigmoid(x)
def _layernorm(x, axis=-1, eps=1e-5):
    m = x.mean(dim=axis, keepdim=True)
    v = x.var(dim=axis, keepdim=True, unbiased=False)
    return (x - m) / torch.sqrt(v + eps)
def _scatter_add(tgt, idx, src, axis=0):
    return tgt.clone().index_add_(axis, idx, src)
def _segment_sum(src, seg, n):
    out = torch.zeros((n,) + src.shape[1:], dtype=src.dtype)
    return out.index_add_(0, seg, src)
def _pad(x, pw):
    flat = tuple(v for pair in reversed(pw) for v in pair)
    return torch.nn.functional.pad(x, flat)

kernel_name = 'parallel_sum__sliding_local_dilated__glu_gated_bilinear__prompt'

def setup_inputs():

    _w = (lambda a: (lambda t: t.to(torch.bfloat16) if t.is_floating_point() else t)(torch.as_tensor(a)))
    def _A_setup():
        B, S, D = 1, 2048, 512
        return {
            "x": _w((lambda *s: torch.randn(*s, dtype=torch.bfloat16) * 0.05)(B, S, D)),
            "wqkv": _w((lambda *s: torch.randn(*s, dtype=torch.bfloat16) * 0.05)(D, 3 * D)),
            "wo": _w((lambda *s: torch.randn(*s, dtype=torch.bfloat16) * 0.05)(D, D)),
        }
    _A_in = _A_setup()

    def _B_setup():
        B, S, D, F = 1, 2048, 512, 1792
        return {
            "x": _w((lambda *s: torch.randn(*s, dtype=torch.bfloat16) * 0.05)(B, S, D)),
            "w_gate": _w((lambda *s: torch.randn(*s, dtype=torch.bfloat16) * 0.8)(D, F) * (D ** -0.5)),
            "w_up": _w((lambda *s: torch.randn(*s, dtype=torch.bfloat16) * 0.8)(D, F) * (D ** -0.5)),
            "w_down": _w((lambda *s: torch.randn(*s, dtype=torch.bfloat16) * 0.8)(F, D) * (F ** -0.5)),
        }
    _B_in = _B_setup()

    return {
        "A_x": _A_in["x"],
        "A_wqkv": _A_in["wqkv"],
        "A_wo": _A_in["wo"],
        "B_x": _B_in["x"],
        "B_w_gate": _B_in["w_gate"],
        "B_w_up": _B_in["w_up"],
        "B_w_down": _B_in["w_down"],
    }

def reference(A_x, A_wqkv, A_wo, B_x, B_w_gate, B_w_up, B_w_down):
    def _A_ref(x, wqkv, wo):
        B, S, D = x.shape
        H = 32; Dh = D // H
        W, dil = 8, 2
        qkv = (lambda x, *d: x.permute(*d))((x @ wqkv).reshape(B, S, 3, H, Dh), 2, 0, 3, 1, 4)
        q, k, v = qkv[0], qkv[1], qkv[2]
        scale = Dh ** -0.5
        pos = torch.arange(S)
        off = torch.arange(W) * dil
        idx = pos[:, None] - off[None, :]
        mask = idx >= 0
        idx_c = torch.where(mask, idx, 0).reshape(-1)
        kg = k[:, :, idx_c, :].reshape(B, H, S, W, Dh)
        vg = v[:, :, idx_c, :].reshape(B, H, S, W, Dh)
        logits = torch.einsum("bhsd,bhswd->bhsw", q, kg) * scale
        logits = torch.where(mask[None, None, :, :], logits, -1e9)
        attn = _softmax(logits, axis=-1)
        o = torch.einsum("bhsw,bhswd->bhsd", attn, vg)
        return (lambda x, *d: x.permute(*d))(o, 0, 2, 1, 3).reshape(B, S, D) @ wo

    def _B_ref(x, w_gate, w_up, w_down):
        g = torch.einsum("bsd,df->bsf", x, w_gate)
        u = torch.einsum("bsd,df->bsf", x, w_up)
        h = g * u
        return torch.einsum("bsf,fd->bsd", h, w_down)

    x = A_x
    xn = _layernorm(x, axis=-1)
    return x + _A_ref(xn, A_wqkv, A_wo) + _B_ref(xn, B_w_gate, B_w_up, B_w_down)
```

```asm
; @launch grid=(256,1,1) block=(512,1,1) lds=163840
.amdgcn_target "amdgcn-amd-amdhsa--gfx950"
.text
.globl parallel_sum__sliding_local_dilated__glu_gated_bilinear__prompt_kernel
.p2align 8
.type parallel_sum__sliding_local_dilated__glu_gated_bilinear__prompt_kernel,@function
parallel_sum__sliding_local_dilated__glu_gated_bilinear__prompt_kernel:
    s_cmp_ge_u32 s2, 256
    s_cbranch_scc1 k1_done
    s_load_dwordx16 s[76:91], s[0:1], 0
    s_load_dwordx4 s[92:95], s[0:1], 64
    v_lshrrev_b32 v1, 6, v0
    v_and_b32 v0, 63, v0
    s_and_b32 s60, s2, 7
    s_lshr_b32 s61, s2, 3
    v_readfirstlane_b32 s46, v1
    s_lshr_b32 s50, s60, 2
    s_lshl_b32 s50, s50, 3
    s_and_b32 s62, s61, 7
    s_add_u32 s50, s50, s62
    s_and_b32 s47, s46, 3
    s_and_b32 s51, s60, 3
    s_lshl_b32 s51, s51, 1
    s_bfe_u32 s62, s61, 0x10003
    s_add_u32 s51, s51, s62
    s_lshr_b32 s48, s61, 4
    s_lshl_b32 s52, s48, 3
    s_add_u32 s52, s52, s51
    s_mov_b32 s6, 2097152
    s_mov_b32 s7, 0x00020000
    s_mov_b32 s10, 1572864
    s_mov_b32 s11, 0x00020000
    s_mov_b32 s14, 1835008
    s_mov_b32 s15, 0x00020000
    s_mov_b32 s18, 1835008
    s_mov_b32 s19, 0x00020000
    s_mov_b32 s22, 12189696
    s_mov_b32 s23, 0x00020000
    s_mov_b32 s26, 256
    s_mov_b32 s27, 0x00020000
    s_mov_b32 s30, 1835008
    s_mov_b32 s31, 0x00020000
    s_mov_b32 s34, 524288
    s_mov_b32 s35, 0x00020000
    s_mov_b32 s38, 2097152
    s_mov_b32 s39, 0x00020000
    s_mul_i32 s74, s51, 160
    s_add_u32 s74, s74, 512
    s_and_b32 s75, s51, 1
    s_lshl_b32 s72, s75, 5
    s_add_u32 s72, s72, s74
    s_add_u32 s73, s74, 128
    s_cmp_lg_u32 s75, 0
    s_cselect_b32 s73, s74, s73
    s_cmp_lt_u32 s46, 4
    s_cbranch_scc1 cons
    v_lshrrev_b32 v58, 3, v0
    s_lshl_b32 s3, s47, 3
    v_add_u32 v56, s3, v58
    v_and_b32 v57, 7, v0
    v_bfe_u32 v59, v0, 4, 1
    v_lshlrev_b32 v59, 2, v59
    v_xor_b32 v57, v57, v59
    s_and_b32 s3, s47, 1
    s_lshl_b32 s3, s3, 1
    v_xor_b32 v57, s3, v57
    v_lshlrev_b32 v57, 4, v57
    s_lshl_b32 s43, s47, 10
    s_lshl_b32 s44, s47, 12
    s_lshl_b32 s45, s47, 9
    s_mov_b32 s53, 0x3f803f80
    s_lshl_b32 s3, s50, 7
    s_lshl_b32 s60, s47, 5
    s_add_u32 s3, s3, s60
    v_lshlrev_b32 v59, 1, v58
    v_add_u32 v59, s3, v59
    v_lshlrev_b32 v59, 10, v59
    v_and_b32 v60, 7, v0
    v_lshrrev_b32 v61, 4, v0
    v_xor_b32 v60, v60, v61
    v_lshlrev_b32 v60, 4, v60
    v_add_u32 v6, v59, v60
    v_xor_b32 v60, 64, v60
    v_add_u32 v7, v59, v60
    v_add_u32 v7, 0x4000, v7
    s_and_b32 s3, s50, 7
    s_mul_i32 s3, s3, 1
    s_mul_i32 s40, s3, 196608
    s_mul_i32 s41, s3, 229376
    s_lshl_b32 s42, s3, 7
    s_cmp_lg_u32 s48, 0
    s_cbranch_scc1 prodB
    s_movk_i32 s60, 3072
    v_mul_lo_u32 v58, v56, s60
    s_lshl_b32 s3, s51, 7
    v_add_u32 v58, s3, v58
    v_add_u32 v2, v58, v57
    s_movk_i32 s60, 3584
    v_mul_lo_u32 v58, v56, s60
    v_add_u32 v58, s3, v58
    v_add_u32 v3, v58, v57
    v_xor_b32 v57, 32, v57
    v_add_u32 v4, v58, v57
    s_lshr_b32 s3, s47, 1
    s_lshl_b32 s60, s50, 7
    s_add_u32 s3, s3, s60
    s_sub_u32 s3, s3, 16
    s_and_b32 s60, s47, 1
    s_lshl_b32 s60, s60, 3
    s_add_u32 s3, s3, s60
    v_lshrrev_b32 v58, 3, v0
    v_lshlrev_b32 v58, 1, v58
    v_add_u32 v58, s3, v58
    v_lshlrev_b32 v58, 10, v58
    v_and_b32 v59, 7, v0
    v_lshrrev_b32 v60, 4, v0
    v_xor_b32 v59, v59, v60
    s_lshl_b32 s60, s47, 1
    v_xor_b32 v59, s60, v59
    v_and_b32 v59, 7, v59
    v_lshlrev_b32 v59, 4, v59
    v_add_u32 v8, v58, v59
    s_mov_b32 s58, -1
    s_mov_b32 s59, 0
    s_cmp_lg_u32 s50, 0
    s_cbranch_scc1 pA_hok
    v_mov_b32 v8, 0x80000000
pA_hok:
    s_waitcnt lgkmcnt(0)
    s_mov_b64 s[4:5], s[76:77]
    s_mov_b64 s[8:9], s[78:79]
    s_mov_b64 s[12:13], s[84:85]
    s_mov_b64 s[16:17], s[86:87]
    s_mov_b64 s[20:21], s[94:95]
    s_mov_b64 s[24:25], s[92:93]
    s_mov_b64 s[28:29], s[88:89]
    s_mov_b64 s[32:33], s[80:81]
    s_mov_b64 s[36:37], s[90:91]
    s_add_u32 m0, s43, 0
    s_nop 0
    buffer_load_dwordx4 v2, s[8:11], s40 offen offset:0 lds
    s_add_u32 m0, s43, 3072
    s_nop 0
    buffer_load_dwordx4 v2, s[8:11], s40 offen offset:1024 lds
    s_add_u32 m0, s43, 6144
    s_nop 0
    buffer_load_dwordx4 v2, s[8:11], s40 offen offset:2048 lds
    s_add_u32 m0, s43, 12288
    s_nop 0
    buffer_load_dwordx4 v3, s[12:15], s41 offen offset:0 lds
    s_add_u32 m0, s43, 16384
    s_nop 0
    buffer_load_dwordx4 v4, s[16:19], s41 offen offset:0 lds
    s_add_u32 s40, s40, 98304
    s_cmp_eq_u32 s40, 1572864
    s_cselect_b32 s40, 0, s40
    s_add_u32 s41, s41, 114688
    s_cmp_eq_u32 s41, 1835008
    s_cselect_b32 s41, 0, s41
    s_add_u32 m0, s44, 102400
    s_nop 0
    buffer_load_dwordx4 v6, s[4:7], s42 offen offset:0 lds
    s_add_u32 m0, s44, 103424
    s_nop 0
    buffer_load_dwordx4 v7, s[4:7], s42 offen offset:0 lds
    s_add_u32 m0, s44, 103424
    s_nop 0
    buffer_load_dwordx4 v6, s[4:7], s42 offen offset:1024 lds
    s_add_u32 m0, s44, 104448
    s_nop 0
    buffer_load_dwordx4 v7, s[4:7], s42 offen offset:1024 lds
    s_add_u32 m0, s45, 118784
    s_mov_b64 exec, s[58:59]
    buffer_load_dwordx4 v8, s[4:7], s42 offen lds
    s_mov_b64 exec, -1
    s_add_u32 s42, s42, 128
    s_and_b32 s42, s42, 1023
    s_add_u32 m0, s43, 20480
    s_nop 0
    buffer_load_dwordx4 v2, s[8:11], s40 offen offset:0 lds
    s_add_u32 m0, s43, 23552
    s_nop 0
    buffer_load_dwordx4 v2, s[8:11], s40 offen offset:1024 lds
    s_add_u32 m0, s43, 26624
    s_nop 0
    buffer_load_dwordx4 v2, s[8:11], s40 offen offset:2048 lds
    s_add_u32 m0, s43, 32768
    s_nop 0
    buffer_load_dwordx4 v3, s[12:15], s41 offen offset:0 lds
    s_add_u32 m0, s43, 36864
    s_nop 0
    buffer_load_dwordx4 v4, s[16:19], s41 offen offset:0 lds
    s_add_u32 s40, s40, 98304
    s_cmp_eq_u32 s40, 1572864
    s_cselect_b32 s40, 0, s40
    s_add_u32 s41, s41, 114688
    s_cmp_eq_u32 s41, 1835008
    s_cselect_b32 s41, 0, s41
    s_add_u32 m0, s44, 120832
    s_nop 0
    buffer_load_dwordx4 v6, s[4:7], s42 offen offset:0 lds
    s_add_u32 m0, s44, 121856
    s_nop 0
    buffer_load_dwordx4 v7, s[4:7], s42 offen offset:0 lds
    s_add_u32 m0, s44, 121856
    s_nop 0
    buffer_load_dwordx4 v6, s[4:7], s42 offen offset:1024 lds
    s_add_u32 m0, s44, 122880
    s_nop 0
    buffer_load_dwordx4 v7, s[4:7], s42 offen offset:1024 lds
    s_add_u32 m0, s45, 137216
    s_mov_b64 exec, s[58:59]
    buffer_load_dwordx4 v8, s[4:7], s42 offen lds
    s_mov_b64 exec, -1
    s_add_u32 s42, s42, 128
    s_and_b32 s42, s42, 1023
    s_load_dword s76, s[20:21], 16384
    v_lshrrev_b32 v58, 4, v0
    v_bfe_u32 v59, v0, 2, 2
    v_lshlrev_b32 v60, 3, v58
    v_add_u32 v60, v60, v59
    v_lshlrev_b32 v60, 7, v60
    v_and_b32 v61, 3, v0
    v_lshlrev_b32 v61, 3, v61
    v_add_u32 v60, v60, v61
    v_and_b32 v61, 2, v59
    v_and_b32 v62, 1, v58
    v_xor_b32 v61, v61, v62
    v_xor_b32 v61, s47, v61
    v_lshlrev_b32 v61, 5, v61
    v_add_u32 v9, v60, v61
    v_add_u32 v10, 61440, v9
    s_lshl_b32 s3, s50, 7
    s_lshl_b32 s60, s47, 6
    s_add_u32 s61, s3, s60
    v_add_u32 v14, s61, v0
    v_lshlrev_b32 v14, 3, v14
    v_add_u32 v15, s60, v0
    v_lshlrev_b32 v15, 3, v15
    v_add_u32 v15, 160256, v15
    s_cmp_lt_u32 s47, 2
    s_cbranch_scc1 psa_doneA
    v_and_b32 v58, 7, v0
    v_bfe_u32 v59, v0, 3, 1
    v_lshlrev_b32 v59, 4, v59
    v_add_u32 v58, v58, v59
    s_sub_u32 s3, s3, 24
    v_add_u32 v14, s3, v58
    v_lshlrev_b32 v14, 3, v14
    v_and_b32 v15, 15, v0
    v_lshlrev_b32 v15, 3, v15
    v_add_u32 v15, 161280, v15
    s_cmp_lg_u32 s50, 0
    s_cbranch_scc1 psa_doneA
    v_mov_b32 v14, 0x80000000
psa_doneA:
    s_and_b32 s60, s2, 7
    s_lshr_b32 s61, s2, 3
    s_lshr_b32 s77, s61, 2
    s_lshl_b32 s78, s60, 2
    s_and_b32 s62, s61, 3
    s_add_u32 s78, s78, s62
    s_xor_b32 s79, s77, s78
    s_and_b32 s79, s79, 1
    s_lshl_b32 s79, s79, 2
    s_add_u32 s79, s79, s46
    s_and_b32 s79, s79, 7
    s_mul_i32 s60, s77, 144
    s_mul_i32 s61, s79, 10
    s_add_u32 s61, s61, 64
    s_lshl_b32 s62, s79, 2
    s_add_u32 s80, s60, s61
    s_lshl_b32 s80, s80, 11
    s_add_u32 s80, s80, 9830400
    s_add_u32 s82, s60, s62
    s_lshl_b32 s82, s82, 11
    s_add_u32 s82, s82, 9830400
    s_add_u32 s81, s82, 65536
    s_mul_i32 s60, s78, 288
    s_add_u32 s84, s60, s61
    s_lshl_b32 s84, s84, 10
    s_add_u32 s84, s84, 65536
    s_add_u32 s86, s60, s62
    s_lshl_b32 s86, s86, 10
    s_add_u32 s86, s86, 65536
    s_add_u32 s85, s86, 32768
    s_lshr_b32 s60, s78, 1
    s_lshl_b32 s60, s60, 4
    s_add_u32 s88, s60, s79
    s_lshl_b32 s88, s88, 7
    s_add_u32 s88, s88, 28672
    s_add_u32 s87, s88, 1024
    s_lshr_b32 s60, s77, 1
    s_and_b32 s61, s78, 2
    s_add_u32 s60, s60, s61
    s_and_b32 s60, s60, 3
    s_mul_i32 s61, s60, 5
    s_add_u32 s61, s61, 1
    s_lshr_b32 s61, s61, 1
    s_lshl_b32 s61, s61, 2
    s_mov_b32 s96, 0x76543210
    s_mov_b32 s97, 0x98
    s_sub_u32 s62, 40, s61
    s_lshl_b64 s[98:99], s[96:97], s62
    s_lshr_b64 s[96:97], s[96:97], s61
    s_or_b64 s[96:97], s[96:97], s[98:99]
    s_lshl_b32 s3, s60, 4
    s_and_b32 s61, s77, 1
    s_lshl_b32 s61, s61, 3
    s_add_u32 s3, s3, s61
    s_mov_b32 s98, 0x23222120
    s_mov_b32 s99, 0x03020100
    s_sub_u32 s62, 64, s3
    s_lshl_b64 s[60:61], s[98:99], s62
    s_lshr_b64 s[98:99], s[98:99], s3
    s_or_b64 s[98:99], s[98:99], s[60:61]
    s_lshl_b32 s3, s50, 8
    s_add_u32 s3, s3, 16640
    s_lshl_b32 s60, s52, 8
    s_add_u32 s60, s60, 20736
    s_lshl_b32 s61, s77, 8
    s_add_u32 s61, s61, 24832
    v_lshlrev_b32 v58, 4, v0
    v_mov_b32 v13, s3
    v_add_u32 v59, s3, v58
    v_cmp_gt_u32 vcc, 4, v0
    s_nop 1
    v_cndmask_b32 v13, v13, v59, vcc
    v_subrev_u32 v59, 4, v0
    v_cmp_gt_u32 vcc, 4, v59
    s_sub_u32 s60, s60, 64
    v_add_u32 v59, s60, v58
    v_cndmask_b32 v13, v13, v59, vcc
    v_subrev_u32 v59, 8, v0
    v_cmp_gt_u32 vcc, 8, v59
    s_sub_u32 s61, s61, 128
    v_add_u32 v59, s61, v58
    v_cndmask_b32 v13, v13, v59, vcc
    s_sub_u32 s61, s3, 208
    s_cmp_eq_u32 s50, 0
    s_cselect_b32 s61, s3, s61
    v_cmp_eq_u32 vcc, 16, v0
    v_mov_b32 v59, s61
    s_nop 0
    v_cndmask_b32 v13, v13, v59, vcc
    s_lshl_b32 s61, s52, 2
    s_add_u32 s3, s3, s61
    s_lshl_b32 s61, s50, 2
    s_add_u32 s60, s60, s61
    s_add_u32 s60, s60, 64
    s_and_b32 s61, s2, 7
    s_lshl_b32 s61, s61, 8
    s_lshr_b32 s62, s2, 3
    s_lshl_b32 s62, s62, 2
    s_add_u32 s61, s61, s62
    s_add_u32 s61, s61, 24832
    v_mov_b32 v21, s3
    v_mov_b32 v59, s60
    v_cmp_eq_u32 vcc, 1, v0
    s_nop 1
    v_cndmask_b32 v21, v21, v59, vcc
    v_mov_b32 v59, s61
    v_cmp_eq_u32 vcc, 2, v0
    s_nop 1
    v_cndmask_b32 v21, v21, v59, vcc
    v_lshlrev_b32 v55, 4, v0
    v_lshlrev_b32 v22, 4, v0
    v_lshrrev_b32 v58, 5, v0
    v_lshlrev_b32 v58, 2, v58
    v_bfe_u32 v59, v0, 4, 1
    v_lshlrev_b32 v59, 3, v59
    v_add_u32 v58, v58, v59
    v_lshlrev_b32 v58, 10, v58
    v_and_b32 v59, 15, v0
    v_lshlrev_b32 v59, 3, v59
    v_add_u32 v58, v58, v59
    s_and_b32 s60, s2, 7
    s_lshl_b32 s61, s60, 7
    v_add_u32 v54, s61, v58
    s_lshr_b32 s61, s2, 3
    s_lshl_b32 s62, s61, 2
    s_add_u32 s62, s62, s47
    s_mul_i32 s60, s60, 144
    s_add_u32 s92, s60, s62
    s_lshl_b32 s92, s92, 11
    s_add_u32 s92, s92, 9830400
    s_add_u32 s93, s60, s61
    s_add_u32 s93, s93, 128
    s_lshl_b32 s93, s93, 11
    s_add_u32 s93, s93, 9830400
    s_add_u32 s91, s61, 96
    s_lshl_b32 s91, s91, 14
    s_cmp_lt_u32 s62, 32
    s_cselect_b32 s68, s32, s28
    s_cselect_b32 s69, s33, s29
    s_cselect_b32 s70, s34, s30
    s_mov_b32 s71, 0x00020000
    s_cselect_b32 s3, 0, 32
    s_sub_u32 s90, s62, s3
    s_lshl_b32 s90, s90, 14
    v_mov_b32 v53, v55
    v_mov_b32 v52, v54
    s_and_b32 s3, s61, 3
    s_cmp_eq_u32 s3, s47
    s_cselect_b32 s3, 1, 0
    s_cmp_lt_u32 s61, 16
    s_cselect_b32 s3, s3, 0
    s_cmp_lg_u32 s3, 0
    s_cbranch_scc1 pk_actA
    v_mov_b32 v53, 0x80000000
    v_mov_b32 v52, 0x80000000
pk_actA:
    s_lshl_b32 s94, s52, 6
    s_add_u32 s94, s94, s47
    s_mul_i32 s94, s94, 320
    s_add_u32 s94, s94, 9502720
    s_mul_i32 s95, s50, 1280
    s_add_u32 s95, s95, s94
    v_and_b32 v58, 15, v0
    v_lshrrev_b32 v59, 1, v58
    v_lshrrev_b32 v60, 4, v0
    v_xor_b32 v59, v59, v60
    v_lshlrev_b32 v59, 4, v59
    v_lshlrev_b32 v58, 7, v58
    v_add_u32 v58, v58, v59
    v_add_u32 v11, 118784, v58
    v_xor_b32 v12, 64, v11
    v_mov_b32 v24, 0
    v_mov_b32 v25, 0
    v_mov_b32 v26, 0
    v_mov_b32 v27, 0
    v_mov_b32 v28, 0
    v_mov_b32 v29, 0
    v_mov_b32 v30, 0
    v_mov_b32 v31, 0
    s_setprio 3
    s_waitcnt lgkmcnt(0)
    s_waitcnt vmcnt(10)
    s_barrier
    s_add_u32 m0, s43, 40960
    s_nop 0
    buffer_load_dwordx4 v2, s[8:11], s40 offen offset:0 lds
    s_add_u32 m0, s43, 44032
    s_nop 0
    buffer_load_dwordx4 v2, s[8:11], s40 offen offset:1024 lds
    s_add_u32 m0, s43, 47104
    s_nop 0
    buffer_load_dwordx4 v2, s[8:11], s40 offen offset:2048 lds
    s_add_u32 m0, s43, 53248
    s_nop 0
    buffer_load_dwordx4 v3, s[12:15], s41 offen offset:0 lds
    s_add_u32 m0, s43, 57344
    s_nop 0
    buffer_load_dwordx4 v4, s[16:19], s41 offen offset:0 lds
    s_add_u32 s40, s40, 98304
    s_cmp_eq_u32 s40, 1572864
    s_cselect_b32 s40, 0, s40
    s_add_u32 s41, s41, 114688
    s_cmp_eq_u32 s41, 1835008
    s_cselect_b32 s41, 0, s41
    s_add_u32 m0, s44, 139264
    s_nop 0
    buffer_load_dwordx4 v6, s[4:7], s42 offen offset:0 lds
    s_add_u32 m0, s44, 140288
    s_nop 0
    buffer_load_dwordx4 v7, s[4:7], s42 offen offset:0 lds
    s_add_u32 m0, s44, 140288
    s_nop 0
    buffer_load_dwordx4 v6, s[4:7], s42 offen offset:1024 lds
    s_add_u32 m0, s44, 141312
    s_nop 0
    buffer_load_dwordx4 v7, s[4:7], s42 offen offset:1024 lds
    s_add_u32 m0, s45, 155648
    s_mov_b64 exec, s[58:59]
    buffer_load_dwordx4 v8, s[4:7], s42 offen lds
    s_mov_b64 exec, -1
    s_add_u32 s42, s42, 128
    s_and_b32 s42, s42, 1023
    ds_read_b64_tr_b16 v[76:77], v9 offset:4096
    ds_read_b64_tr_b16 v[78:79], v9 offset:4608
    ds_read_b64_tr_b16 v[80:81], v9 offset:8192
    ds_read_b64_tr_b16 v[82:83], v9 offset:8704
    ds_read_b128 v[84:87], v11 offset:0
    s_lshr_b32 s3, s50, 3
    s_cmp_lg_u32 s3, 0
    s_cbranch_scc1 cs_skipA0
    ds_read_b64_tr_b16 v[32:33], v9 offset:0
    ds_read_b64_tr_b16 v[34:35], v9 offset:512
    ds_read_b64_tr_b16 v[36:37], v9 offset:4096
    ds_read_b64_tr_b16 v[38:39], v9 offset:4608
    ds_read_b64_tr_b16 v[40:41], v9 offset:8192
    ds_read_b64_tr_b16 v[42:43], v9 offset:8704
    ds_read_b64_tr_b16 v[44:45], v9 offset:12288
    ds_read_b64_tr_b16 v[46:47], v9 offset:12800
    ds_read_b64_tr_b16 v[48:49], v9 offset:16384
    ds_read_b64_tr_b16 v[50:51], v9 offset:16896
    v_mov_b32 v16, 0
    v_mov_b32 v17, 0
    v_mov_b32 v18, 0
    v_mov_b32 v19, 0
    v_mov_b32 v20, 0
    v_lshlrev_b32 v56, 2, v0
    s_waitcnt lgkmcnt(0)
    v_dot2c_f32_bf16 v16, s53, v32
    v_dot2c_f32_bf16 v17, s53, v36
    v_dot2c_f32_bf16 v18, s53, v40
    v_dot2c_f32_bf16 v19, s53, v44
    v_dot2c_f32_bf16 v20, s53, v48
    v_dot2c_f32_bf16 v16, s53, v33
    v_dot2c_f32_bf16 v17, s53, v37
    v_dot2c_f32_bf16 v18, s53, v41
    v_dot2c_f32_bf16 v19, s53, v45
    v_dot2c_f32_bf16 v20, s53, v49
    v_dot2c_f32_bf16 v16, s53, v34
    v_dot2c_f32_bf16 v17, s53, v38
    v_dot2c_f32_bf16 v18, s53, v42
    v_dot2c_f32_bf16 v19, s53, v46
    v_dot2c_f32_bf16 v20, s53, v50
    v_dot2c_f32_bf16 v16, s53, v35
    v_dot2c_f32_bf16 v17, s53, v39
    v_dot2c_f32_bf16 v18, s53, v43
    v_dot2c_f32_bf16 v19, s53, v47
    v_dot2c_f32_bf16 v20, s53, v51
    s_nop 0
    v_permlane32_swap_b32 v16, v18
    v_permlane32_swap_b32 v17, v19
    v_mov_b32 v58, v20
    v_add_f32 v16, v16, v18
    v_add_f32 v17, v17, v19
    v_permlane32_swap_b32 v20, v58
    v_add_f32 v20, v20, v58
    v_permlane16_swap_b32 v16, v17
    v_mov_b32 v58, v20
    v_add_f32 v16, v16, v17
    s_nop 0
    v_permlane16_swap_b32 v20, v58
    v_add_f32 v20, v20, v58
    buffer_store_dword v16, v56, s[20:23], s95 offen sc1
    s_mov_b64 exec, 0xffff
    buffer_store_dword v20, v56, s[20:23], s95 offen offset:256 sc1
    s_mov_b64 exec, -1
cs_skipA0:
    s_waitcnt vmcnt(15)
    s_waitcnt lgkmcnt(0)
    s_barrier
    s_add_u32 m0, s43, 61440
    s_nop 0
    buffer_load_dwordx4 v2, s[8:11], s40 offen offset:0 lds
    s_add_u32 m0, s43, 64512
    s_nop 0
    buffer_load_dwordx4 v2, s[8:11], s40 offen offset:1024 lds
    s_add_u32 m0, s43, 67584
    s_nop 0
    buffer_load_dwordx4 v2, s[8:11], s40 offen offset:2048 lds
    s_add_u32 m0, s43, 73728
    s_nop 0
    buffer_load_dwordx4 v3, s[12:15], s41 offen offset:0 lds
    s_add_u32 m0, s43, 77824
    s_nop 0
    buffer_load_dwordx4 v4, s[16:19], s41 offen offset:0 lds
    s_add_u32 s40, s40, 98304
    s_cmp_eq_u32 s40, 1572864
    s_cselect_b32 s40, 0, s40
    s_add_u32 s41, s41, 114688
    s_cmp_eq_u32 s41, 1835008
    s_cselect_b32 s41, 0, s41
    s_add_u32 m0, s43, 81920
    s_nop 0
    buffer_load_dwordx4 v2, s[8:11], s40 offen offset:0 lds
    s_add_u32 m0, s43, 84992
    s_nop 0
    buffer_load_dwordx4 v2, s[8:11], s40 offen offset:1024 lds
    s_add_u32 m0, s43, 88064
    s_nop 0
    buffer_load_dwordx4 v2, s[8:11], s40 offen offset:2048 lds
    s_add_u32 m0, s43, 94208
    s_nop 0
    buffer_load_dwordx4 v3, s[12:15], s41 offen offset:0 lds
    s_add_u32 m0, s43, 98304
    s_nop 0
    buffer_load_dwordx4 v4, s[16:19], s41 offen offset:0 lds
    s_add_u32 s40, s40, 98304
    s_cmp_eq_u32 s40, 1572864
    s_cselect_b32 s40, 0, s40
    s_add_u32 s41, s41, 114688
    s_cmp_eq_u32 s41, 1835008
    s_cselect_b32 s41, 0, s41
    v_mfma_f32_16x16x32_bf16 v[24:27], v[76:79], v[84:87], v[24:27]
    v_mfma_f32_16x16x32_bf16 v[28:31], v[80:83], v[84:87], v[28:31]
    ds_read_b64_tr_b16 v[88:89], v9 offset:24576
    ds_read_b64_tr_b16 v[90:91], v9 offset:25088
    ds_read_b64_tr_b16 v[92:93], v9 offset:28672
    ds_read_b64_tr_b16 v[94:95], v9 offset:29184
    ds_read_b128 v[96:99], v12 offset:0
    s_lshr_b32 s3, s50, 3
    s_cmp_lg_u32 s3, 1
    s_cbranch_scc1 cs_skipA1
    ds_read_b64_tr_b16 v[32:33], v9 offset:20480
    ds_read_b64_tr_b16 v[34:35], v9 offset:20992
    ds_read_b64_tr_b16 v[36:37], v9 offset:24576
    ds_read_b64_tr_b16 v[38:39], v9 offset:25088
    ds_read_b64_tr_b16 v[40:41], v9 offset:28672
    ds_read_b64_tr_b16 v[42:43], v9 offset:29184
    ds_read_b64_tr_b16 v[44:45], v9 offset:32768
    ds_read_b64_tr_b16 v[46:47], v9 offset:33280
    ds_read_b64_tr_b16 v[48:49], v9 offset:36864
    ds_read_b64_tr_b16 v[50:51], v9 offset:37376
    v_mov_b32 v16, 0
    v_mov_b32 v17, 0
    v_mov_b32 v18, 0
    v_mov_b32 v19, 0
    v_mov_b32 v20, 0
    v_lshlrev_b32 v56, 2, v0
    s_waitcnt lgkmcnt(0)
    v_dot2c_f32_bf16 v16, s53, v32
    v_dot2c_f32_bf16 v17, s53, v36
    v_dot2c_f32_bf16 v18, s53, v40
    v_dot2c_f32_bf16 v19, s53, v44
    v_dot2c_f32_bf16 v20, s53, v48
    v_dot2c_f32_bf16 v16, s53, v33
    v_dot2c_f32_bf16 v17, s53, v37
    v_dot2c_f32_bf16 v18, s53, v41
    v_dot2c_f32_bf16 v19, s53, v45
    v_dot2c_f32_bf16 v20, s53, v49
    v_dot2c_f32_bf16 v16, s53, v34
    v_dot2c_f32_bf16 v17, s53, v38
    v_dot2c_f32_bf16 v18, s53, v42
    v_dot2c_f32_bf16 v19, s53, v46
    v_dot2c_f32_bf16 v20, s53, v50
    v_dot2c_f32_bf16 v16, s53, v35
    v_dot2c_f32_bf16 v17, s53, v39
    v_dot2c_f32_bf16 v18, s53, v43
    v_dot2c_f32_bf16 v19, s53, v47
    v_dot2c_f32_bf16 v20, s53, v51
    s_nop 0
    v_permlane32_swap_b32 v16, v18
    v_permlane32_swap_b32 v17, v19
    v_mov_b32 v58, v20
    v_add_f32 v16, v16, v18
    v_add_f32 v17, v17, v19
    v_permlane32_swap_b32 v20, v58
    v_add_f32 v20, v20, v58
    v_permlane16_swap_b32 v16, v17
    v_mov_b32 v58, v20
    v_add_f32 v16, v16, v17
    s_nop 0
    v_permlane16_swap_b32 v20, v58
    v_add_f32 v20, v20, v58
    buffer_store_dword v16, v56, s[20:23], s95 offen sc1
    s_mov_b64 exec, 0xffff
    buffer_store_dword v20, v56, s[20:23], s95 offen offset:256 sc1
    s_mov_b64 exec, -1
cs_skipA1:
    s_waitcnt vmcnt(15)
    s_waitcnt lgkmcnt(0)
    s_barrier
    s_add_u32 m0, s43, 0
    s_nop 0
    buffer_load_dwordx4 v2, s[8:11], s40 offen offset:0 lds
    s_add_u32 m0, s43, 3072
    s_nop 0
    buffer_load_dwordx4 v2, s[8:11], s40 offen offset:1024 lds
    s_add_u32 m0, s43, 6144
    s_nop 0
    buffer_load_dwordx4 v2, s[8:11], s40 offen offset:2048 lds
    s_add_u32 m0, s43, 12288
    s_nop 0
    buffer_load_dwordx4 v3, s[12:15], s41 offen offset:0 lds
    s_add_u32 m0, s43, 16384
    s_nop 0
    buffer_load_dwordx4 v4, s[16:19], s41 offen offset:0 lds
    s_add_u32 s40, s40, 98304
    s_cmp_eq_u32 s40, 1572864
    s_cselect_b32 s40, 0, s40
    s_add_u32 s41, s41, 114688
    s_cmp_eq_u32 s41, 1835008
    s_cselect_b32 s41, 0, s41
    s_add_u32 m0, s44, 102400
    s_nop 0
    buffer_load_dwordx4 v6, s[4:7], s42 offen offset:0 lds
    s_add_u32 m0, s44, 103424
    s_nop 0
    buffer_load_dwordx4 v7, s[4:7], s42 offen offset:0 lds
    s_add_u32 m0, s44, 103424
    s_nop 0
    buffer_load_dwordx4 v6, s[4:7], s42 offen offset:1024 lds
    s_add_u32 m0, s44, 104448
    s_nop 0
    buffer_load_dwordx4 v7, s[4:7], s42 offen offset:1024 lds
    s_add_u32 m0, s45, 118784
    s_mov_b64 exec, s[58:59]
    buffer_load_dwordx4 v8, s[4:7], s42 offen lds
    s_mov_b64 exec, -1
    s_add_u32 s42, s42, 128
    s_and_b32 s42, s42, 1023
    v_mfma_f32_16x16x32_bf16 v[24:27], v[88:91], v[96:99], v[24:27]
    v_mfma_f32_16x16x32_bf16 v[28:31], v[92:95], v[96:99], v[28:31]
    ds_read_b64_tr_b16 v[76:77], v9 offset:45056
    ds_read_b64_tr_b16 v[78:79], v9 offset:45568
    ds_read_b64_tr_b16 v[80:81], v9 offset:49152
    ds_read_b64_tr_b16 v[82:83], v9 offset:49664
    ds_read_b128 v[84:87], v11 offset:18432
    s_waitcnt vmcnt(15)
    s_waitcnt lgkmcnt(0)
    s_barrier
    s_add_u32 m0, s43, 20480
    s_nop 0
    buffer_load_dwordx4 v2, s[8:11], s40 offen offset:0 lds
    s_add_u32 m0, s43, 23552
    s_nop 0
    buffer_load_dwordx4 v2, s[8:11], s40 offen offset:1024 lds
    s_add_u32 m0, s43, 26624
    s_nop 0
    buffer_load_dwordx4 v2, s[8:11], s40 offen offset:2048 lds
    s_add_u32 m0, s43, 32768
    s_nop 0
    buffer_load_dwordx4 v3, s[12:15], s41 offen offset:0 lds
    s_add_u32 m0, s43, 36864
    s_nop 0
    buffer_load_dwordx4 v4, s[16:19], s41 offen offset:0 lds
    s_add_u32 s40, s40, 98304
    s_cmp_eq_u32 s40, 1572864
    s_cselect_b32 s40, 0, s40
    s_add_u32 s41, s41, 114688
    s_cmp_eq_u32 s41, 1835008
    s_cselect_b32 s41, 0, s41
    v_mfma_f32_16x16x32_bf16 v[24:27], v[76:79], v[84:87], v[24:27]
    v_mfma_f32_16x16x32_bf16 v[28:31], v[80:83], v[84:87], v[28:31]
    ds_read_b64_tr_b16 v[88:89], v10 offset:4096
    ds_read_b64_tr_b16 v[90:91], v10 offset:4608
    ds_read_b64_tr_b16 v[92:93], v10 offset:8192
    ds_read_b64_tr_b16 v[94:95], v10 offset:8704
    ds_read_b128 v[96:99], v12 offset:18432
    buffer_load_dwordx2 v[60:61], v54, s[68:71], s90 offen offset:0
    buffer_load_dwordx2 v[62:63], v54, s[68:71], s90 offen offset:1024
    buffer_load_dwordx2 v[64:65], v54, s[68:71], s90 offen offset:2048
    buffer_load_dwordx2 v[66:67], v54, s[68:71], s90 offen offset:3072
    buffer_load_dwordx2 v[68:69], v52, s[28:31], s91 offen offset:0
    buffer_load_dwordx2 v[70:71], v52, s[28:31], s91 offen offset:1024
    buffer_load_dwordx2 v[72:73], v52, s[28:31], s91 offen offset:2048
    buffer_load_dwordx2 v[74:75], v52, s[28:31], s91 offen offset:3072
    s_waitcnt vmcnt(23)
    s_waitcnt lgkmcnt(0)
    s_barrier
    s_add_u32 m0, s43, 40960
    s_nop 0
    buffer_load_dwordx4 v2, s[8:11], s40 offen offset:0 lds
    s_add_u32 m0, s43, 44032
    s_nop 0
    buffer_load_dwordx4 v2, s[8:11], s40 offen offset:1024 lds
    s_add_u32 m0, s43, 47104
    s_nop 0
    buffer_load_dwordx4 v2, s[8:11], s40 offen offset:2048 lds
    s_add_u32 m0, s43, 53248
    s_nop 0
    buffer_load_dwordx4 v3, s[12:15], s41 offen offset:0 lds
    s_add_u32 m0, s43, 57344
    s_nop 0
    buffer_load_dwordx4 v4, s[16:19], s41 offen offset:0 lds
    s_add_u32 s40, s40, 98304
    s_cmp_eq_u32 s40, 1572864
    s_cselect_b32 s40, 0, s40
    s_add_u32 s41, s41, 114688
    s_cmp_eq_u32 s41, 1835008
    s_cselect_b32 s41, 0, s41
    s_add_u32 m0, s44, 120832
    s_nop 0
    buffer_load_dwordx4 v6, s[4:7], s42 offen offset:0 lds
    s_add_u32 m0, s44, 121856
    s_nop 0
    buffer_load_dwordx4 v7, s[4:7], s42 offen offset:0 lds
    s_add_u32 m0, s44, 121856
    s_nop 0
    buffer_load_dwordx4 v6, s[4:7], s42 offen offset:1024 lds
    s_add_u32 m0, s44, 122880
    s_nop 0
    buffer_load_dwordx4 v7, s[4:7], s42 offen offset:1024 lds
    s_add_u32 m0, s45, 137216
    s_mov_b64 exec, s[58:59]
    buffer_load_dwordx4 v8, s[4:7], s42 offen lds
    s_mov_b64 exec, -1
    s_add_u32 s42, s42, 128
    s_and_b32 s42, s42, 1023
    v_mfma_f32_16x16x32_bf16 v[24:27], v[88:91], v[96:99], v[24:27]
    v_mfma_f32_16x16x32_bf16 v[28:31], v[92:95], v[96:99], v[28:31]
    ds_read_b64_tr_b16 v[76:77], v10 offset:24576
    ds_read_b64_tr_b16 v[78:79], v10 offset:25088
    ds_read_b64_tr_b16 v[80:81], v10 offset:28672
    ds_read_b64_tr_b16 v[82:83], v10 offset:29184
    ds_read_b128 v[84:87], v11 offset:36864
    s_waitcnt vmcnt(14)
    s_mov_b32 s60, 0x05040100
    s_mov_b32 s61, 0x07060302
    v_perm_b32 v40, v62, v60, s60
    v_perm_b32 v42, v62, v60, s61
    v_perm_b32 v41, v66, v64, s60
    v_perm_b32 v43, v66, v64, s61
    v_perm_b32 v44, v63, v61, s60
    v_perm_b32 v46, v63, v61, s61
    v_perm_b32 v45, v67, v65, s60
    v_perm_b32 v47, v67, v65, s61
    v_permlane16_swap_b32 v40, v42
    v_permlane16_swap_b32 v41, v43
    v_permlane16_swap_b32 v44, v46
    v_permlane16_swap_b32 v45, v47
    buffer_store_dwordx4 v[40:43], v55, s[20:23], s92 offen sc1
    buffer_store_dwordx4 v[44:47], v55, s[20:23], s92 offen offset:1024 sc1
    s_waitcnt vmcnt(30)
    s_waitcnt lgkmcnt(0)
    s_barrier
    s_add_u32 m0, s43, 61440
    s_nop 0
    buffer_load_dwordx4 v2, s[8:11], s40 offen offset:0 lds
    s_add_u32 m0, s43, 64512
    s_nop 0
    buffer_load_dwordx4 v2, s[8:11], s40 offen offset:1024 lds
    s_add_u32 m0, s43, 67584
    s_nop 0
    buffer_load_dwordx4 v2, s[8:11], s40 offen offset:2048 lds
    s_add_u32 m0, s43, 73728
    s_nop 0
    buffer_load_dwordx4 v3, s[12:15], s41 offen offset:0 lds
    s_add_u32 m0, s43, 77824
    s_nop 0
    buffer_load_dwordx4 v4, s[16:19], s41 offen offset:0 lds
    s_add_u32 s40, s40, 98304
    s_cmp_eq_u32 s40, 1572864
    s_cselect_b32 s40, 0, s40
    s_add_u32 s41, s41, 114688
    s_cmp_eq_u32 s41, 1835008
    s_cselect_b32 s41, 0, s41
    v_mfma_f32_16x16x32_bf16 v[24:27], v[76:79], v[84:87], v[24:27]
    v_mfma_f32_16x16x32_bf16 v[28:31], v[80:83], v[84:87], v[28:31]
    ds_read_b64_tr_b16 v[88:89], v9 offset:4096
    ds_read_b64_tr_b16 v[90:91], v9 offset:4608
    ds_read_b64_tr_b16 v[92:93], v9 offset:8192
    ds_read_b64_tr_b16 v[94:95], v9 offset:8704
    ds_read_b128 v[96:99], v12 offset:36864
    s_waitcnt vmcnt(17)
    s_mov_b32 s60, 0x05040100
    s_mov_b32 s61, 0x07060302
    v_perm_b32 v40, v70, v68, s60
    v_perm_b32 v42, v70, v68, s61
    v_perm_b32 v41, v74, v72, s60
    v_perm_b32 v43, v74, v72, s61
    v_perm_b32 v44, v71, v69, s60
    v_perm_b32 v46, v71, v69, s61
    v_perm_b32 v45, v75, v73, s60
    v_perm_b32 v47, v75, v73, s61
    v_permlane16_swap_b32 v40, v42
    v_permlane16_swap_b32 v41, v43
    v_permlane16_swap_b32 v44, v46
    v_permlane16_swap_b32 v45, v47
    buffer_store_dwordx4 v[40:43], v53, s[20:23], s93 offen sc1
    buffer_store_dwordx4 v[44:47], v53, s[20:23], s93 offen offset:1024 sc1
    s_waitcnt vmcnt(27)
    s_waitcnt lgkmcnt(0)
    s_barrier
    s_add_u32 m0, s43, 81920
    s_nop 0
    buffer_load_dwordx4 v2, s[8:11], s40 offen offset:0 lds
    s_add_u32 m0, s43, 84992
    s_nop 0
    buffer_load_dwordx4 v2, s[8:11], s40 offen offset:1024 lds
    s_add_u32 m0, s43, 88064
    s_nop 0
    buffer_load_dwordx4 v2, s[8:11], s40 offen offset:2048 lds
    s_add_u32 m0, s43, 94208
    s_nop 0
    buffer_load_dwordx4 v3, s[12:15], s41 offen offset:0 lds
    s_add_u32 m0, s43, 98304
    s_nop 0
    buffer_load_dwordx4 v4, s[16:19], s41 offen offset:0 lds
    s_add_u32 s40, s40, 98304
    s_cmp_eq_u32 s40, 1572864
    s_cselect_b32 s40, 0, s40
    s_add_u32 s41, s41, 114688
    s_cmp_eq_u32 s41, 1835008
    s_cselect_b32 s41, 0, s41
    s_add_u32 m0, s44, 139264
    s_nop 0
    buffer_load_dwordx4 v6, s[4:7], s42 offen offset:0 lds
    s_add_u32 m0, s44, 140288
    s_nop 0
    buffer_load_dwordx4 v7, s[4:7], s42 offen offset:0 lds
    s_add_u32 m0, s44, 140288
    s_nop 0
    buffer_load_dwordx4 v6, s[4:7], s42 offen offset:1024 lds
    s_add_u32 m0, s44, 141312
    s_nop 0
    buffer_load_dwordx4 v7, s[4:7], s42 offen offset:1024 lds
    s_add_u32 m0, s45, 155648
    s_mov_b64 exec, s[58:59]
    buffer_load_dwordx4 v8, s[4:7], s42 offen lds
    s_mov_b64 exec, -1
    s_add_u32 s42, s42, 128
    s_and_b32 s42, s42, 1023
    v_mfma_f32_16x16x32_bf16 v[24:27], v[88:91], v[96:99], v[24:27]
    v_mfma_f32_16x16x32_bf16 v[28:31], v[92:95], v[96:99], v[28:31]
    ds_read_b64_tr_b16 v[76:77], v9 offset:24576
    ds_read_b64_tr_b16 v[78:79], v9 offset:25088
    ds_read_b64_tr_b16 v[80:81], v9 offset:28672
    ds_read_b64_tr_b16 v[82:83], v9 offset:29184
    ds_read_b128 v[84:87], v11 offset:0
    s_waitcnt vmcnt(24)
    s_waitcnt lgkmcnt(0)
    s_barrier
    s_add_u32 m0, s43, 0
    s_nop 0
    buffer_load_dwordx4 v2, s[8:11], s40 offen offset:0 lds
    s_add_u32 m0, s43, 3072
    s_nop 0
    buffer_load_dwordx4 v2, s[8:11], s40 offen offset:1024 lds
    s_add_u32 m0, s43, 6144
    s_nop 0
    buffer_load_dwordx4 v2, s[8:11], s40 offen offset:2048 lds
    s_add_u32 m0, s43, 12288
    s_nop 0
    buffer_load_dwordx4 v3, s[12:15], s41 offen offset:0 lds
    s_add_u32 m0, s43, 16384
    s_nop 0
    buffer_load_dwordx4 v4, s[16:19], s41 offen offset:0 lds
    s_add_u32 s40, s40, 98304
    s_cmp_eq_u32 s40, 1572864
    s_cselect_b32 s40, 0, s40
    s_add_u32 s41, s41, 114688
    s_cmp_eq_u32 s41, 1835008
    s_cselect_b32 s41, 0, s41
    v_mfma_f32_16x16x32_bf16 v[24:27], v[76:79], v[84:87], v[24:27]
    v_mfma_f32_16x16x32_bf16 v[28:31], v[80:83], v[84:87], v[28:31]
    ds_read_b64_tr_b16 v[88:89], v9 offset:45056
    ds_read_b64_tr_b16 v[90:91], v9 offset:45568
    ds_read_b64_tr_b16 v[92:93], v9 offset:49152
    ds_read_b64_tr_b16 v[94:95], v9 offset:49664
    ds_read_b128 v[96:99], v12 offset:0
    s_waitcnt vmcnt(15)
    s_waitcnt vmcnt(17)
    s_waitcnt lgkmcnt(0)
    s_barrier
    s_cmp_lg_u32 s47, 0
    s_cbranch_scc1 pf_skipA
    s_add_u32 s61, s76, 1
    s_mov_b64 exec, 7
    v_mov_b32 v58, s61
    buffer_store_dword v58, v21, s[20:23], 0 offen sc1
    s_mov_b64 exec, -1
pf_skipA:
    s_add_u32 m0, s43, 20480
    s_nop 0
    buffer_load_dwordx4 v2, s[8:11], s40 offen offset:0 lds
    s_add_u32 m0, s43, 23552
    s_nop 0
    buffer_load_dwordx4 v2, s[8:11], s40 offen offset:1024 lds
    s_add_u32 m0, s43, 26624
    s_nop 0
    buffer_load_dwordx4 v2, s[8:11], s40 offen offset:2048 lds
    s_add_u32 m0, s43, 32768
    s_nop 0
    buffer_load_dwordx4 v3, s[12:15], s41 offen offset:0 lds
    s_add_u32 m0, s43, 36864
    s_nop 0
    buffer_load_dwordx4 v4, s[16:19], s41 offen offset:0 lds
    s_add_u32 s40, s40, 98304
    s_cmp_eq_u32 s40, 1572864
    s_cselect_b32 s40, 0, s40
    s_add_u32 s41, s41, 114688
    s_cmp_eq_u32 s41, 1835008
    s_cselect_b32 s41, 0, s41
    s_add_u32 m0, s44, 102400
    s_nop 0
    buffer_load_dwordx4 v6, s[4:7], s42 offen offset:0 lds
    s_add_u32 m0, s44, 103424
    s_nop 0
    buffer_load_dwordx4 v7, s[4:7], s42 offen offset:0 lds
    s_add_u32 m0, s44, 103424
    s_nop 0
    buffer_load_dwordx4 v6, s[4:7], s42 offen offset:1024 lds
    s_add_u32 m0, s44, 104448
    s_nop 0
    buffer_load_dwordx4 v7, s[4:7], s42 offen offset:1024 lds
    s_add_u32 m0, s45, 118784
    s_mov_b64 exec, s[58:59]
    buffer_load_dwordx4 v8, s[4:7], s42 offen lds
    s_mov_b64 exec, -1
    s_add_u32 s42, s42, 128
    s_and_b32 s42, s42, 1023
    v_mfma_f32_16x16x32_bf16 v[24:27], v[88:91], v[96:99], v[24:27]
    v_mfma_f32_16x16x32_bf16 v[28:31], v[92:95], v[96:99], v[28:31]
    ds_read_b64_tr_b16 v[76:77], v10 offset:4096
    ds_read_b64_tr_b16 v[78:79], v10 offset:4608
    ds_read_b64_tr_b16 v[80:81], v10 offset:8192
    ds_read_b64_tr_b16 v[82:83], v10 offset:8704
    ds_read_b128 v[84:87], v11 offset:18432
    s_waitcnt vmcnt(20)
    s_waitcnt lgkmcnt(0)
    s_barrier
    s_add_u32 m0, s43, 40960
    s_nop 0
    buffer_load_dwordx4 v2, s[8:11], s40 offen offset:0 lds
    s_add_u32 m0, s43, 44032
    s_nop 0
    buffer_load_dwordx4 v2, s[8:11], s40 offen offset:1024 lds
    s_add_u32 m0, s43, 47104
    s_nop 0
    buffer_load_dwordx4 v2, s[8:11], s40 offen offset:2048 lds
    s_add_u32 m0, s43, 53248
    s_nop 0
    buffer_load_dwordx4 v3, s[12:15], s41 offen offset:0 lds
    s_add_u32 m0, s43, 57344
    s_nop 0
    buffer_load_dwordx4 v4, s[16:19], s41 offen offset:0 lds
    s_add_u32 s40, s40, 98304
    s_cmp_eq_u32 s40, 1572864
    s_cselect_b32 s40, 0, s40
    s_add_u32 s41, s41, 114688
    s_cmp_eq_u32 s41, 1835008
    s_cselect_b32 s41, 0, s41
    s_add_u32 m0, s43, 61440
    s_nop 0
    buffer_load_dwordx4 v2, s[8:11], s40 offen offset:0 lds
    s_add_u32 m0, s43, 64512
    s_nop 0
    buffer_load_dwordx4 v2, s[8:11], s40 offen offset:1024 lds
    s_add_u32 m0, s43, 67584
    s_nop 0
    buffer_load_dwordx4 v2, s[8:11], s40 offen offset:2048 lds
    s_add_u32 m0, s43, 73728
    s_nop 0
    buffer_load_dwordx4 v3, s[12:15], s41 offen offset:0 lds
    s_add_u32 m0, s43, 77824
    s_nop 0
    buffer_load_dwordx4 v4, s[16:19], s41 offen offset:0 lds
    s_add_u32 s40, s40, 98304
    s_cmp_eq_u32 s40, 1572864
    s_cselect_b32 s40, 0, s40
    s_add_u32 s41, s41, 114688
    s_cmp_eq_u32 s41, 1835008
    s_cselect_b32 s41, 0, s41
    v_mfma_f32_16x16x32_bf16 v[24:27], v[76:79], v[84:87], v[24:27]
    v_mfma_f32_16x16x32_bf16 v[28:31], v[80:83], v[84:87], v[28:31]
    ds_read_b64_tr_b16 v[88:89], v10 offset:24576
    ds_read_b64_tr_b16 v[90:91], v10 offset:25088
    ds_read_b64_tr_b16 v[92:93], v10 offset:28672
    ds_read_b64_tr_b16 v[94:95], v10 offset:29184
    ds_read_b128 v[96:99], v12 offset:18432
    s_waitcnt vmcnt(20)
    s_waitcnt lgkmcnt(0)
    s_barrier
    s_add_u32 m0, s43, 81920
    s_nop 0
    buffer_load_dwordx4 v2, s[8:11], s40 offen offset:0 lds
    s_add_u32 m0, s43, 84992
    s_nop 0
    buffer_load_dwordx4 v2, s[8:11], s40 offen offset:1024 lds
    s_add_u32 m0, s43, 88064
    s_nop 0
    buffer_load_dwordx4 v2, s[8:11], s40 offen offset:2048 lds
    s_add_u32 m0, s43, 94208
    s_nop 0
    buffer_load_dwordx4 v3, s[12:15], s41 offen offset:0 lds
    s_add_u32 m0, s43, 98304
    s_nop 0
    buffer_load_dwordx4 v4, s[16:19], s41 offen offset:0 lds
    s_add_u32 s40, s40, 98304
    s_cmp_eq_u32 s40, 1572864
    s_cselect_b32 s40, 0, s40
    s_add_u32 s41, s41, 114688
    s_cmp_eq_u32 s41, 1835008
    s_cselect_b32 s41, 0, s41
    s_add_u32 m0, s44, 120832
    s_nop 0
    buffer_load_dwordx4 v6, s[4:7], s42 offen offset:0 lds
    s_add_u32 m0, s44, 121856
    s_nop 0
    buffer_load_dwordx4 v7, s[4:7], s42 offen offset:0 lds
    s_add_u32 m0, s44, 121856
    s_nop 0
    buffer_load_dwordx4 v6, s[4:7], s42 offen offset:1024 lds
    s_add_u32 m0, s44, 122880
    s_nop 0
    buffer_load_dwordx4 v7, s[4:7], s42 offen offset:1024 lds
    s_add_u32 m0, s45, 137216
    s_mov_b64 exec, s[58:59]
    buffer_load_dwordx4 v8, s[4:7], s42 offen lds
    s_mov_b64 exec, -1
    v_mfma_f32_16x16x32_bf16 v[24:27], v[88:91], v[96:99], v[24:27]
    v_mfma_f32_16x16x32_bf16 v[28:31], v[92:95], v[96:99], v[28:31]
    ds_read_b64_tr_b16 v[76:77], v9 offset:4096
    ds_read_b64_tr_b16 v[78:79], v9 offset:4608
    ds_read_b64_tr_b16 v[80:81], v9 offset:8192
    ds_read_b64_tr_b16 v[82:83], v9 offset:8704
    ds_read_b128 v[84:87], v11 offset:36864
    s_waitcnt vmcnt(25)
    s_waitcnt lgkmcnt(0)
    s_barrier
    s_cmp_lg_u32 s47, 0
    s_cbranch_scc1 pl_skipA
    buffer_load_dwordx4 v[68:71], v13, s[20:23], 0 offen sc1
pl_skipA:
    s_add_u32 m0, s43, 0
    s_nop 0
    buffer_load_dwordx4 v2, s[8:11], s40 offen offset:0 lds
    s_add_u32 m0, s43, 3072
    s_nop 0
    buffer_load_dwordx4 v2, s[8:11], s40 offen offset:1024 lds
    s_add_u32 m0, s43, 6144
    s_nop 0
    buffer_load_dwordx4 v2, s[8:11], s40 offen offset:2048 lds
    s_add_u32 m0, s43, 12288
    s_nop 0
    buffer_load_dwordx4 v3, s[12:15], s41 offen offset:0 lds
    s_add_u32 m0, s43, 16384
    s_nop 0
    buffer_load_dwordx4 v4, s[16:19], s41 offen offset:0 lds
    v_mfma_f32_16x16x32_bf16 v[24:27], v[76:79], v[84:87], v[24:27]
    v_mfma_f32_16x16x32_bf16 v[28:31], v[80:83], v[84:87], v[28:31]
    ds_read_b64_tr_b16 v[88:89], v9 offset:24576
    ds_read_b64_tr_b16 v[90:91], v9 offset:25088
    ds_read_b64_tr_b16 v[92:93], v9 offset:28672
    ds_read_b64_tr_b16 v[94:95], v9 offset:29184
    ds_read_b128 v[96:99], v12 offset:36864
    s_cmp_lg_u32 s47, 0
    s_cbranch_scc1 pp_doneA
    s_mov_b32 s63, 0
    s_add_u32 s61, s76, 1
    s_waitcnt vmcnt(5)
pp_spinA:
    v_xor_b32 v58, s61, v68
    v_xor_b32 v59, s61, v69
    v_xor_b32 v60, s61, v70
    v_xor_b32 v61, s61, v71
    v_or_b32 v58, v58, v59
    v_or3_b32 v58, v58, v60, v61
    v_cmp_ne_u32 vcc, 0, v58
    s_cbranch_vccz pp_doneA
    s_add_u32 s63, s63, 1
    s_cmp_ge_u32 s63, 0x8000
    s_cbranch_scc1 pp_doneA
    s_sleep 4
    buffer_load_dwordx4 v[68:71], v13, s[20:23], 0 offen sc1
    s_waitcnt vmcnt(0)
    s_branch pp_spinA
pp_doneA:
    s_waitcnt vmcnt(20)
    s_waitcnt lgkmcnt(0)
    s_barrier
    v_mfma_f32_16x16x32_bf16 v[24:27], v[88:91], v[96:99], v[24:27]
    v_mfma_f32_16x16x32_bf16 v[28:31], v[92:95], v[96:99], v[28:31]
    ds_read_b64_tr_b16 v[76:77], v9 offset:45056
    ds_read_b64_tr_b16 v[78:79], v9 offset:45568
    ds_read_b64_tr_b16 v[80:81], v9 offset:49152
    ds_read_b64_tr_b16 v[82:83], v9 offset:49664
    ds_read_b128 v[84:87], v11 offset:0
    buffer_load_dwordx2 v[56:57], v14, s[20:23], 0 offen sc1
    v_lshlrev_b32 v58, 2, v0
    v_lshrrev_b32 v59, 4, v0
    v_mul_u32_u24 v59, 1280, v59
    v_and_b32 v60, 15, v0
    v_lshlrev_b32 v60, 2, v60
    v_add_u32 v59, v59, v60
    s_add_u32 s3, s94, 0
    buffer_load_dword v32, v58, s[20:23], s3 offen offset:0 sc1
    buffer_load_dword v33, v58, s[20:23], s3 offen offset:1280 sc1
    buffer_load_dword v34, v58, s[20:23], s3 offen offset:2560 sc1
    s_add_u32 s3, s94, 3840
    buffer_load_dword v35, v58, s[20:23], s3 offen offset:0 sc1
    buffer_load_dword v36, v58, s[20:23], s3 offen offset:1280 sc1
    buffer_load_dword v37, v58, s[20:23], s3 offen offset:2560 sc1
    s_add_u32 s3, s94, 7680
    buffer_load_dword v38, v58, s[20:23], s3 offen offset:0 sc1
    buffer_load_dword v39, v58, s[20:23], s3 offen offset:1280 sc1
    buffer_load_dword v40, v58, s[20:23], s3 offen offset:2560 sc1
    s_add_u32 s3, s94, 11520
    buffer_load_dword v41, v58, s[20:23], s3 offen offset:0 sc1
    buffer_load_dword v42, v58, s[20:23], s3 offen offset:1280 sc1
    buffer_load_dword v43, v58, s[20:23], s3 offen offset:2560 sc1
    s_add_u32 s3, s94, 15360
    buffer_load_dword v44, v58, s[20:23], s3 offen offset:0 sc1
    buffer_load_dword v45, v58, s[20:23], s3 offen offset:1280 sc1
    buffer_load_dword v46, v58, s[20:23], s3 offen offset:2560 sc1
    s_add_u32 s3, s94, 19200
    buffer_load_dword v47, v58, s[20:23], s3 offen offset:0 sc1
    s_add_u32 s3, s94, 0
    buffer_load_dword v48, v59, s[20:23], s3 offen offset:256 sc1
    s_add_u32 s3, s94, 5120
    buffer_load_dword v49, v59, s[20:23], s3 offen offset:256 sc1
    s_add_u32 s3, s94, 10240
    buffer_load_dword v50, v59, s[20:23], s3 offen offset:256 sc1
    s_add_u32 s3, s94, 15360
    buffer_load_dword v51, v59, s[20:23], s3 offen offset:256 sc1
    s_bfe_u32 s89, s96, 0x40000
    s_lshl_b32 s89, s89, 11
    s_add_u32 s89, s89, s80
    buffer_load_dwordx4 v[176:179], v55, s[20:23], s89 offen offset:0 sc1
    buffer_load_dwordx4 v[180:183], v55, s[20:23], s89 offen offset:1024 sc1
    s_bfe_u32 s89, s96, 0x40004
    s_lshl_b32 s89, s89, 11
    s_add_u32 s89, s89, s80
    buffer_load_dwordx4 v[184:187], v55, s[20:23], s89 offen offset:0 sc1
    buffer_load_dwordx4 v[188:191], v55, s[20:23], s89 offen offset:1024 sc1
    s_waitcnt vmcnt(40)
    s_waitcnt lgkmcnt(0)
    s_barrier
    v_mfma_f32_16x16x32_bf16 v[24:27], v[76:79], v[84:87], v[24:27]
    v_mfma_f32_16x16x32_bf16 v[28:31], v[80:83], v[84:87], v[28:31]
    ds_read_b64_tr_b16 v[88:89], v10 offset:4096
    ds_read_b64_tr_b16 v[90:91], v10 offset:4608
    ds_read_b64_tr_b16 v[92:93], v10 offset:8192
    ds_read_b64_tr_b16 v[94:95], v10 offset:8704
    ds_read_b128 v[96:99], v12 offset:0
    s_bfe_u32 s89, s96, 0x40008
    s_lshl_b32 s89, s89, 11
    s_add_u32 s89, s89, s80
    buffer_load_dwordx4 v[112:115], v55, s[20:23], s89 offen offset:0 sc1
    buffer_load_dwordx4 v[116:119], v55, s[20:23], s89 offen offset:1024 sc1
    s_bfe_u32 s89, s96, 0x4000c
    s_lshl_b32 s89, s89, 11
    s_add_u32 s89, s89, s80
    buffer_load_dwordx4 v[120:123], v55, s[20:23], s89 offen offset:0 sc1
    buffer_load_dwordx4 v[124:127], v55, s[20:23], s89 offen offset:1024 sc1
    s_bfe_u32 s89, s96, 0x40010
    s_lshl_b32 s89, s89, 11
    s_add_u32 s89, s89, s80
    buffer_load_dwordx4 v[192:195], v55, s[20:23], s89 offen offset:0 sc1
    buffer_load_dwordx4 v[196:199], v55, s[20:23], s89 offen offset:1024 sc1
    s_bfe_u32 s89, s96, 0x40014
    s_lshl_b32 s89, s89, 11
    s_add_u32 s89, s89, s80
    buffer_load_dwordx4 v[200:203], v55, s[20:23], s89 offen offset:0 sc1
    buffer_load_dwordx4 v[204:207], v55, s[20:23], s89 offen offset:1024 sc1
    s_waitcnt vmcnt(32)
    ds_write_b64 v15, v[56:57]
    s_waitcnt vmcnt(12)
    v_pk_add_f32 v[32:33], v[32:33], v[40:41]
    v_pk_add_f32 v[34:35], v[34:35], v[42:43]
    v_pk_add_f32 v[36:37], v[36:37], v[44:45]
    v_pk_add_f32 v[38:39], v[38:39], v[46:47]
    v_pk_add_f32 v[48:49], v[48:49], v[50:51]
    v_pk_add_f32 v[32:33], v[32:33], v[36:37]
    v_pk_add_f32 v[34:35], v[34:35], v[38:39]
    v_add_f32 v20, v48, v49
    v_pk_add_f32 v[32:33], v[32:33], v[34:35]
    v_mov_b32 v58, v20
    v_add_f32 v16, v32, v33
    s_nop 0
    v_permlane32_swap_b32 v20, v58
    v_add_f32 v20, v20, v58
    v_mov_b32 v58, v20
    s_nop 1
    v_permlane16_swap_b32 v20, v58
    v_add_f32 v20, v20, v58
    v_cvt_pk_bf16_f32 v60, v16, v16
    v_and_b32 v62, 0xffff0000, v60
    v_sub_f32 v16, v16, v62
    v_cvt_pk_bf16_f32 v63, v16, v16
    v_and_b32 v62, 0xffff0000, v63
    v_sub_f32 v16, v16, v62
    v_cvt_pk_bf16_f32 v61, v16, v16
    v_and_b32 v60, 0xffff, v60
    v_or_b32 v60, v60, v62
    v_and_b32 v61, 0xffff, v61
    v_cvt_pk_bf16_f32 v66, v20, v20
    v_and_b32 v68, 0xffff0000, v66
    v_sub_f32 v20, v20, v68
    v_cvt_pk_bf16_f32 v69, v20, v20
    v_and_b32 v68, 0xffff0000, v69
    v_sub_f32 v20, v20, v68
    v_cvt_pk_bf16_f32 v67, v20, v20
    v_and_b32 v66, 0xffff, v66
    v_or_b32 v66, v66, v68
    v_and_b32 v67, 0xffff, v67
    v_and_b32 v58, 15, v0
    v_lshlrev_b32 v58, 3, v58
    s_lshl_b32 s3, s47, 7
    s_add_u32 s3, s3, 157696
    v_add_u32 v103, s3, v58
    v_lshrrev_b32 v59, 4, v0
    v_lshlrev_b32 v59, 9, v59
    v_add_u32 v59, v59, v103
    ds_write_b64 v59, v[60:61]
    ds_write_b64 v103, v[66:67] offset:2048
    s_waitcnt lgkmcnt(0)
    s_waitcnt vmcnt(38)
    s_waitcnt lgkmcnt(0)
    s_barrier
    v_mfma_f32_16x16x32_bf16 v[24:27], v[88:91], v[96:99], v[24:27]
    v_mfma_f32_16x16x32_bf16 v[28:31], v[92:95], v[96:99], v[28:31]
    ds_read_b64_tr_b16 v[76:77], v10 offset:24576
    ds_read_b64_tr_b16 v[78:79], v10 offset:25088
    ds_read_b64_tr_b16 v[80:81], v10 offset:28672
    ds_read_b64_tr_b16 v[82:83], v10 offset:29184
    ds_read_b128 v[84:87], v11 offset:18432
    s_bfe_u32 s89, s96, 0x40018
    s_lshl_b32 s89, s89, 11
    s_add_u32 s89, s89, s80
    buffer_load_dwordx4 v[128:131], v55, s[20:23], s89 offen offset:0 sc1
    buffer_load_dwordx4 v[132:135], v55, s[20:23], s89 offen offset:1024 sc1
    s_bfe_u32 s89, s96, 0x4001c
    s_lshl_b32 s89, s89, 11
    s_add_u32 s89, s89, s80
    buffer_load_dwordx4 v[136:139], v55, s[20:23], s89 offen offset:0 sc1
    buffer_load_dwordx4 v[140:143], v55, s[20:23], s89 offen offset:1024 sc1
    s_bfe_u32 s89, s97, 0x40000
    s_lshl_b32 s89, s89, 11
    s_add_u32 s89, s89, s80
    buffer_load_dwordx4 v[208:211], v55, s[20:23], s89 offen offset:0 sc1
    buffer_load_dwordx4 v[212:215], v55, s[20:23], s89 offen offset:1024 sc1
    s_bfe_u32 s89, s97, 0x40004
    s_lshl_b32 s89, s89, 11
    s_add_u32 s89, s89, s80
    buffer_load_dwordx4 v[216:219], v55, s[20:23], s89 offen offset:0 sc1
    buffer_load_dwordx4 v[220:223], v55, s[20:23], s89 offen offset:1024 sc1
    s_waitcnt vmcnt(41)
    s_waitcnt lgkmcnt(0)
    s_barrier
    v_mfma_f32_16x16x32_bf16 v[24:27], v[76:79], v[84:87], v[24:27]
    v_mfma_f32_16x16x32_bf16 v[28:31], v[80:83], v[84:87], v[28:31]
    ds_read_b64_tr_b16 v[88:89], v9 offset:4096
    ds_read_b64_tr_b16 v[90:91], v9 offset:4608
    ds_read_b64_tr_b16 v[92:93], v9 offset:8192
    ds_read_b64_tr_b16 v[94:95], v9 offset:8704
    ds_read_b128 v[96:99], v12 offset:18432
    s_bfe_u32 s89, s98, 0x80000
    s_lshl_b32 s89, s89, 11
    s_add_u32 s89, s89, s82
    buffer_load_dwordx4 v[144:147], v55, s[20:23], s89 offen offset:0 sc1
    buffer_load_dwordx4 v[148:151], v55, s[20:23], s89 offen offset:1024 sc1
    s_bfe_u32 s89, s98, 0x80008
    s_lshl_b32 s89, s89, 11
    s_add_u32 s89, s89, s82
    buffer_load_dwordx4 v[152:155], v55, s[20:23], s89 offen offset:0 sc1
    buffer_load_dwordx4 v[156:159], v55, s[20:23], s89 offen offset:1024 sc1
    s_bfe_u32 s89, s98, 0x80010
    s_lshl_b32 s89, s89, 11
    s_add_u32 s89, s89, s82
    buffer_load_dwordx4 v[224:227], v55, s[20:23], s89 offen offset:0 sc1
    buffer_load_dwordx4 v[228:231], v55, s[20:23], s89 offen offset:1024 sc1
    s_bfe_u32 s89, s98, 0x80018
    s_lshl_b32 s89, s89, 11
    s_add_u32 s89, s89, s82
    buffer_load_dwordx4 v[232:235], v55, s[20:23], s89 offen offset:0 sc1
    buffer_load_dwordx4 v[236:239], v55, s[20:23], s89 offen offset:1024 sc1
    s_waitcnt lgkmcnt(0)
    s_barrier
    v_mfma_f32_16x16x32_bf16 v[24:27], v[88:91], v[96:99], v[24:27]
    v_mfma_f32_16x16x32_bf16 v[28:31], v[92:95], v[96:99], v[28:31]
    s_bfe_u32 s89, s99, 0x80000
    s_lshl_b32 s89, s89, 11
    s_add_u32 s89, s89, s82
    buffer_load_dwordx4 v[160:163], v55, s[20:23], s89 offen offset:0 sc1
    buffer_load_dwordx4 v[164:167], v55, s[20:23], s89 offen offset:1024 sc1
    s_bfe_u32 s89, s99, 0x80008
    s_lshl_b32 s89, s89, 11
    s_add_u32 s89, s89, s82
    buffer_load_dwordx4 v[168:171], v55, s[20:23], s89 offen offset:0 sc1
    buffer_load_dwordx4 v[172:175], v55, s[20:23], s89 offen offset:1024 sc1
    s_bfe_u32 s89, s99, 0x80010
    s_lshl_b32 s89, s89, 11
    s_add_u32 s89, s89, s82
    buffer_load_dwordx4 v[240:243], v55, s[20:23], s89 offen offset:0 sc1
    buffer_load_dwordx4 v[244:247], v55, s[20:23], s89 offen offset:1024 sc1
    s_bfe_u32 s89, s99, 0x80018
    s_lshl_b32 s89, s89, 11
    s_add_u32 s89, s89, s82
    buffer_load_dwordx4 v[248:251], v55, s[20:23], s89 offen offset:0 sc1
    buffer_load_dwordx4 v[252:255], v55, s[20:23], s89 offen offset:1024 sc1
    s_setprio 0
    ds_read_b64 v[60:61], v103 offset:512
    ds_read_b64 v[62:63], v103 offset:1024
    v_and_b32 v59, 15, v0
    v_lshlrev_b32 v59, 3, v59
    v_add_u32 v59, 161280, v59
    ds_read_b64 v[64:65], v59
    v_cmp_gt_u32 vcc, 16, v0
    v_bfe_u32 v68, v0, 4, 1
    v_mul_u32_u24 v68, 2560, v68
    v_bfe_u32 v69, v0, 5, 1
    v_bfe_u32 v70, v0, 3, 1
    v_and_b32 v71, 7, v0
    s_mul_i32 s3, s47, 36864
    s_waitcnt lgkmcnt(0)
    v_cndmask_b32 v66, 0, v64, vcc
    v_and_b32 v67, 0xffff, v66
    s_nop 1
    v_mfma_f32_16x16x16_bf16 v[24:27], v[60:61], v[66:67], v[24:27]
    v_mfma_f32_16x16x16_bf16 v[28:31], v[62:63], v[66:67], v[28:31]
    v_lshlrev_b32 v72, 3, v69
    v_mul_u32_u24 v73, 1280, v70
    v_lshlrev_b32 v74, 4, v71
    v_add_u32 v72, v72, v68
    v_add_u32 v73, v73, v74
    v_add_u32 v72, v72, v73
    v_add_u32 v72, s3, v72
    v_mul_u32_u24 v73, 1280, v69
    v_mul_u32_u24 v74, 640, v70
    v_lshlrev_b32 v75, 3, v71
    v_add_u32 v73, v73, v68
    v_add_u32 v74, v74, v75
    v_add_u32 v73, v73, v74
    v_add_u32 v73, s3, v73
    v_mul_f32 v24, v24, v65
    v_mul_f32 v25, v25, v65
    v_mul_f32 v26, v26, v65
    v_mul_f32 v27, v27, v65
    v_mul_f32 v28, v28, v65
    v_mul_f32 v29, v29, v65
    v_mul_f32 v30, v30, v65
    v_mul_f32 v31, v31, v65
    v_cvt_pk_bf16_f32 v60, v24, v25
    v_cvt_pk_bf16_f32 v61, v26, v27
    v_cvt_pk_bf16_f32 v62, v28, v29
    v_cvt_pk_bf16_f32 v63, v30, v31
    ds_write_b64 v72, v[60:61] offset:25600
    ds_write_b64 v73, v[62:63] offset:30720
    s_waitcnt lgkmcnt(0)
    s_branch attn
prodB:
    s_movk_i32 s60, 3584
    v_mul_lo_u32 v58, v56, s60
    s_lshl_b32 s3, s72, 1
    v_add_u32 v59, s3, v58
    v_add_u32 v2, v59, v57
    v_xor_b32 v60, 32, v57
    v_add_u32 v3, v59, v60
    s_lshl_b32 s3, s73, 1
    v_add_u32 v59, s3, v58
    v_and_b32 v57, 48, v57
    v_and_b32 v60, 48, v60
    v_add_u32 v4, v59, v57
    v_add_u32 v5, v59, v60
    v_bfe_u32 v58, v0, 2, 1
    v_bfe_u32 v59, v0, 4, 1
    v_xor_b32 v58, v58, v59
    v_cmp_eq_u32 vcc, 0, v58
    s_mov_b64 s[54:55], vcc
    v_cmp_eq_u32 vcc, 1, v58
    s_mov_b64 s[56:57], vcc
    s_waitcnt lgkmcnt(0)
    s_mov_b64 s[4:5], s[76:77]
    s_mov_b64 s[8:9], s[78:79]
    s_mov_b64 s[12:13], s[84:85]
    s_mov_b64 s[16:17], s[86:87]
    s_mov_b64 s[20:21], s[94:95]
    s_mov_b64 s[24:25], s[92:93]
    s_mov_b64 s[28:29], s[88:89]
    s_mov_b64 s[32:33], s[80:81]
    s_mov_b64 s[36:37], s[90:91]
    s_add_u32 m0, s43, 0
    s_nop 0
    buffer_load_dwordx4 v2, s[12:15], s41 offen offset:0 lds
    s_add_u32 m0, s43, 3968
    s_nop 0
    buffer_load_dwordx4 v2, s[12:15], s41 offen offset:128 lds
    s_add_u32 m0, s43, 8192
    s_nop 0
    buffer_load_dwordx4 v3, s[16:19], s41 offen offset:0 lds
    s_add_u32 m0, s43, 12160
    s_nop 0
    buffer_load_dwordx4 v3, s[16:19], s41 offen offset:128 lds
    s_add_u32 m0, s43, 16384
    s_mov_b64 exec, s[54:55]
    buffer_load_dwordx4 v4, s[12:15], s41 offen lds
    s_mov_b64 exec, s[56:57]
    buffer_load_dwordx4 v5, s[16:19], s41 offen lds
    s_mov_b64 exec, -1
    s_add_u32 s41, s41, 114688
    s_cmp_eq_u32 s41, 1835008
    s_cselect_b32 s41, 0, s41
    s_add_u32 m0, s44, 102400
    s_nop 0
    buffer_load_dwordx4 v6, s[4:7], s42 offen offset:0 lds
    s_add_u32 m0, s44, 103424
    s_nop 0
    buffer_load_dwordx4 v7, s[4:7], s42 offen offset:0 lds
    s_add_u32 m0, s44, 103424
    s_nop 0
    buffer_load_dwordx4 v6, s[4:7], s42 offen offset:1024 lds
    s_add_u32 m0, s44, 104448
    s_nop 0
    buffer_load_dwordx4 v7, s[4:7], s42 offen offset:1024 lds
    s_add_u32 s42, s42, 128
    s_and_b32 s42, s42, 1023
    s_add_u32 m0, s43, 20480
    s_nop 0
    buffer_load_dwordx4 v2, s[12:15], s41 offen offset:0 lds
    s_add_u32 m0, s43, 24448
    s_nop 0
    buffer_load_dwordx4 v2, s[12:15], s41 offen offset:128 lds
    s_add_u32 m0, s43, 28672
    s_nop 0
    buffer_load_dwordx4 v3, s[16:19], s41 offen offset:0 lds
    s_add_u32 m0, s43, 32640
    s_nop 0
    buffer_load_dwordx4 v3, s[16:19], s41 offen offset:128 lds
    s_add_u32 m0, s43, 36864
    s_mov_b64 exec, s[54:55]
    buffer_load_dwordx4 v4, s[12:15], s41 offen lds
    s_mov_b64 exec, s[56:57]
    buffer_load_dwordx4 v5, s[16:19], s41 offen lds
    s_mov_b64 exec, -1
    s_add_u32 s41, s41, 114688
    s_cmp_eq_u32 s41, 1835008
    s_cselect_b32 s41, 0, s41
    s_add_u32 m0, s44, 120832
    s_nop 0
    buffer_load_dwordx4 v6, s[4:7], s42 offen offset:0 lds
    s_add_u32 m0, s44, 121856
    s_nop 0
    buffer_load_dwordx4 v7, s[4:7], s42 offen offset:0 lds
    s_add_u32 m0, s44, 121856
    s_nop 0
    buffer_load_dwordx4 v6, s[4:7], s42 offen offset:1024 lds
    s_add_u32 m0, s44, 122880
    s_nop 0
    buffer_load_dwordx4 v7, s[4:7], s42 offen offset:1024 lds
    s_add_u32 s42, s42, 128
    s_and_b32 s42, s42, 1023
    s_load_dword s76, s[20:21], 16384
    v_lshrrev_b32 v58, 4, v0
    v_bfe_u32 v59, v0, 2, 2
    v_lshlrev_b32 v60, 3, v58
    v_add_u32 v60, v60, v59
    v_lshlrev_b32 v60, 7, v60
    v_and_b32 v61, 3, v0
    v_lshlrev_b32 v61, 3, v61
    v_add_u32 v60, v60, v61
    v_and_b32 v61, 2, v59
    v_and_b32 v62, 1, v58
    v_xor_b32 v61, v61, v62
    v_xor_b32 v61, s47, v61
    v_lshlrev_b32 v61, 5, v61
    v_add_u32 v9, v60, v61
    v_add_u32 v10, 61440, v9
    s_lshl_b32 s3, s50, 7
    s_lshl_b32 s60, s47, 6
    s_add_u32 s61, s3, s60
    v_add_u32 v14, s61, v0
    v_lshlrev_b32 v14, 3, v14
    v_add_u32 v15, s60, v0
    v_lshlrev_b32 v15, 3, v15
    v_add_u32 v15, 160256, v15
    s_cmp_lt_u32 s47, 2
    s_cbranch_scc1 psa_doneB
    v_and_b32 v58, 7, v0
    v_bfe_u32 v59, v0, 3, 1
    v_lshlrev_b32 v59, 4, v59
    v_add_u32 v58, v58, v59
    s_sub_u32 s3, s3, 24
    v_add_u32 v14, s3, v58
    v_lshlrev_b32 v14, 3, v14
    v_and_b32 v15, 15, v0
    v_lshlrev_b32 v15, 3, v15
    v_add_u32 v15, 161280, v15
    s_cmp_lg_u32 s50, 0
    s_cbranch_scc1 psa_doneB
    v_mov_b32 v14, 0x80000000
psa_doneB:
    s_and_b32 s60, s2, 7
    s_lshr_b32 s61, s2, 3
    s_lshr_b32 s77, s61, 2
    s_lshl_b32 s78, s60, 2
    s_and_b32 s62, s61, 3
    s_add_u32 s78, s78, s62
    s_xor_b32 s79, s77, s78
    s_and_b32 s79, s79, 1
    s_lshl_b32 s79, s79, 2
    s_add_u32 s79, s79, s46
    s_and_b32 s79, s79, 7
    s_mul_i32 s60, s77, 144
    s_mul_i32 s61, s79, 10
    s_add_u32 s61, s61, 64
    s_lshl_b32 s62, s79, 2
    s_add_u32 s80, s60, s61
    s_lshl_b32 s80, s80, 11
    s_add_u32 s80, s80, 9830400
    s_add_u32 s82, s60, s62
    s_lshl_b32 s82, s82, 11
    s_add_u32 s82, s82, 9830400
    s_add_u32 s81, s82, 65536
    s_mul_i32 s60, s78, 288
    s_add_u32 s84, s60, s61
    s_lshl_b32 s84, s84, 10
    s_add_u32 s84, s84, 65536
    s_add_u32 s86, s60, s62
    s_lshl_b32 s86, s86, 10
    s_add_u32 s86, s86, 65536
    s_add_u32 s85, s86, 32768
    s_lshr_b32 s60, s78, 1
    s_lshl_b32 s60, s60, 4
    s_add_u32 s88, s60, s79
    s_lshl_b32 s88, s88, 7
    s_add_u32 s88, s88, 28672
    s_add_u32 s87, s88, 1024
    s_lshr_b32 s60, s77, 1
    s_and_b32 s61, s78, 2
    s_add_u32 s60, s60, s61
    s_and_b32 s60, s60, 3
    s_mul_i32 s61, s60, 5
    s_add_u32 s61, s61, 1
    s_lshr_b32 s61, s61, 1
    s_lshl_b32 s61, s61, 2
    s_mov_b32 s96, 0x76543210
    s_mov_b32 s97, 0x98
    s_sub_u32 s62, 40, s61
    s_lshl_b64 s[98:99], s[96:97], s62
    s_lshr_b64 s[96:97], s[96:97], s61
    s_or_b64 s[96:97], s[96:97], s[98:99]
    s_lshl_b32 s3, s60, 4
    s_and_b32 s61, s77, 1
    s_lshl_b32 s61, s61, 3
    s_add_u32 s3, s3, s61
    s_mov_b32 s98, 0x23222120
    s_mov_b32 s99, 0x03020100
    s_sub_u32 s62, 64, s3
    s_lshl_b64 s[60:61], s[98:99], s62
    s_lshr_b64 s[98:99], s[98:99], s3
    s_or_b64 s[98:99], s[98:99], s[60:61]
    s_lshl_b32 s3, s50, 8
    s_add_u32 s3, s3, 16640
    s_lshl_b32 s60, s52, 8
    s_add_u32 s60, s60, 20736
    s_lshl_b32 s61, s77, 8
    s_add_u32 s61, s61, 24832
    v_lshlrev_b32 v58, 4, v0
    v_mov_b32 v13, s3
    v_add_u32 v59, s3, v58
    v_cmp_gt_u32 vcc, 4, v0
    s_nop 1
    v_cndmask_b32 v13, v13, v59, vcc
    v_subrev_u32 v59, 4, v0
    v_cmp_gt_u32 vcc, 4, v59
    s_sub_u32 s60, s60, 64
    v_add_u32 v59, s60, v58
    v_cndmask_b32 v13, v13, v59, vcc
    v_subrev_u32 v59, 8, v0
    v_cmp_gt_u32 vcc, 8, v59
    s_sub_u32 s61, s61, 128
    v_add_u32 v59, s61, v58
    v_cndmask_b32 v13, v13, v59, vcc
    s_lshl_b32 s61, s52, 2
    s_add_u32 s3, s3, s61
    s_lshl_b32 s61, s50, 2
    s_add_u32 s60, s60, s61
    s_add_u32 s60, s60, 64
    s_and_b32 s61, s2, 7
    s_lshl_b32 s61, s61, 8
    s_lshr_b32 s62, s2, 3
    s_lshl_b32 s62, s62, 2
    s_add_u32 s61, s61, s62
    s_add_u32 s61, s61, 24832
    v_mov_b32 v21, s3
    v_mov_b32 v59, s60
    v_cmp_eq_u32 vcc, 1, v0
    s_nop 1
    v_cndmask_b32 v21, v21, v59, vcc
    v_mov_b32 v59, s61
    v_cmp_eq_u32 vcc, 2, v0
    s_nop 1
    v_cndmask_b32 v21, v21, v59, vcc
    v_lshlrev_b32 v55, 4, v0
    v_lshlrev_b32 v22, 4, v0
    v_lshrrev_b32 v58, 5, v0
    v_lshlrev_b32 v58, 2, v58
    v_bfe_u32 v59, v0, 4, 1
    v_lshlrev_b32 v59, 3, v59
    v_add_u32 v58, v58, v59
    v_lshlrev_b32 v58, 10, v58
    v_and_b32 v59, 15, v0
    v_lshlrev_b32 v59, 3, v59
    v_add_u32 v58, v58, v59
    s_and_b32 s60, s2, 7
    s_lshl_b32 s61, s60, 7
    v_add_u32 v54, s61, v58
    s_lshr_b32 s61, s2, 3
    s_lshl_b32 s62, s61, 2
    s_add_u32 s62, s62, s47
    s_mul_i32 s60, s60, 144
    s_add_u32 s92, s60, s62
    s_lshl_b32 s92, s92, 11
    s_add_u32 s92, s92, 9830400
    s_add_u32 s93, s60, s61
    s_add_u32 s93, s93, 128
    s_lshl_b32 s93, s93, 11
    s_add_u32 s93, s93, 9830400
    s_add_u32 s91, s61, 96
    s_lshl_b32 s91, s91, 14
    s_cmp_lt_u32 s62, 32
    s_cselect_b32 s68, s32, s28
    s_cselect_b32 s69, s33, s29
    s_cselect_b32 s70, s34, s30
    s_mov_b32 s71, 0x00020000
    s_cselect_b32 s3, 0, 32
    s_sub_u32 s90, s62, s3
    s_lshl_b32 s90, s90, 14
    v_mov_b32 v53, v55
    v_mov_b32 v52, v54
    s_and_b32 s3, s61, 3
    s_cmp_eq_u32 s3, s47
    s_cselect_b32 s3, 1, 0
    s_cmp_lt_u32 s61, 16
    s_cselect_b32 s3, s3, 0
    s_cmp_lg_u32 s3, 0
    s_cbranch_scc1 pk_actB
    v_mov_b32 v53, 0x80000000
    v_mov_b32 v52, 0x80000000
pk_actB:
    s_lshl_b32 s94, s52, 6
    s_add_u32 s94, s94, s47
    s_mul_i32 s94, s94, 320
    s_add_u32 s94, s94, 9502720
    s_mul_i32 s95, s50, 1280
    s_add_u32 s95, s95, s94
    s_setprio 3
    s_waitcnt lgkmcnt(0)
    s_waitcnt vmcnt(10)
    s_barrier
    s_add_u32 m0, s43, 40960
    s_nop 0
    buffer_load_dwordx4 v2, s[12:15], s41 offen offset:0 lds
    s_add_u32 m0, s43, 44928
    s_nop 0
    buffer_load_dwordx4 v2, s[12:15], s41 offen offset:128 lds
    s_add_u32 m0, s43, 49152
    s_nop 0
    buffer_load_dwordx4 v3, s[16:19], s41 offen offset:0 lds
    s_add_u32 m0, s43, 53120
    s_nop 0
    buffer_load_dwordx4 v3, s[16:19], s41 offen offset:128 lds
    s_add_u32 m0, s43, 57344
    s_mov_b64 exec, s[54:55]
    buffer_load_dwordx4 v4, s[12:15], s41 offen lds
    s_mov_b64 exec, s[56:57]
    buffer_load_dwordx4 v5, s[16:19], s41 offen lds
    s_mov_b64 exec, -1
    s_add_u32 s41, s41, 114688
    s_cmp_eq_u32 s41, 1835008
    s_cselect_b32 s41, 0, s41
    s_add_u32 m0, s44, 139264
    s_nop 0
    buffer_load_dwordx4 v6, s[4:7], s42 offen offset:0 lds
    s_add_u32 m0, s44, 140288
    s_nop 0
    buffer_load_dwordx4 v7, s[4:7], s42 offen offset:0 lds
    s_add_u32 m0, s44, 140288
    s_nop 0
    buffer_load_dwordx4 v6, s[4:7], s42 offen offset:1024 lds
    s_add_u32 m0, s44, 141312
    s_nop 0
    buffer_load_dwordx4 v7, s[4:7], s42 offen offset:1024 lds
    s_add_u32 s42, s42, 128
    s_and_b32 s42, s42, 1023
    s_lshr_b32 s3, s50, 3
    s_cmp_lg_u32 s3, 0
    s_cbranch_scc1 cs_skipB0
    ds_read_b64_tr_b16 v[32:33], v9 offset:0
    ds_read_b64_tr_b16 v[34:35], v9 offset:512
    ds_read_b64_tr_b16 v[36:37], v9 offset:4096
    ds_read_b64_tr_b16 v[38:39], v9 offset:4608
    ds_read_b64_tr_b16 v[40:41], v9 offset:8192
    ds_read_b64_tr_b16 v[42:43], v9 offset:8704
    ds_read_b64_tr_b16 v[44:45], v9 offset:12288
    ds_read_b64_tr_b16 v[46:47], v9 offset:12800
    ds_read_b64_tr_b16 v[48:49], v9 offset:16384
    ds_read_b64_tr_b16 v[50:51], v9 offset:16896
    v_mov_b32 v16, 0
    v_mov_b32 v17, 0
    v_mov_b32 v18, 0
    v_mov_b32 v19, 0
    v_mov_b32 v20, 0
    v_lshlrev_b32 v56, 2, v0
    s_waitcnt lgkmcnt(0)
    v_dot2c_f32_bf16 v16, s53, v32
    v_dot2c_f32_bf16 v17, s53, v36
    v_dot2c_f32_bf16 v18, s53, v40
    v_dot2c_f32_bf16 v19, s53, v44
    v_dot2c_f32_bf16 v20, s53, v48
    v_dot2c_f32_bf16 v16, s53, v33
    v_dot2c_f32_bf16 v17, s53, v37
    v_dot2c_f32_bf16 v18, s53, v41
    v_dot2c_f32_bf16 v19, s53, v45
    v_dot2c_f32_bf16 v20, s53, v49
    v_dot2c_f32_bf16 v16, s53, v34
    v_dot2c_f32_bf16 v17, s53, v38
    v_dot2c_f32_bf16 v18, s53, v42
    v_dot2c_f32_bf16 v19, s53, v46
    v_dot2c_f32_bf16 v20, s53, v50
    v_dot2c_f32_bf16 v16, s53, v35
    v_dot2c_f32_bf16 v17, s53, v39
    v_dot2c_f32_bf16 v18, s53, v43
    v_dot2c_f32_bf16 v19, s53, v47
    v_dot2c_f32_bf16 v20, s53, v51
    s_nop 0
    v_permlane32_swap_b32 v16, v18
    v_permlane32_swap_b32 v17, v19
    v_mov_b32 v58, v20
    v_add_f32 v16, v16, v18
    v_add_f32 v17, v17, v19
    v_permlane32_swap_b32 v20, v58
    v_add_f32 v20, v20, v58
    v_permlane16_swap_b32 v16, v17
    v_mov_b32 v58, v20
    v_add_f32 v16, v16, v17
    s_nop 0
    v_permlane16_swap_b32 v20, v58
    v_add_f32 v20, v20, v58
    buffer_store_dword v16, v56, s[20:23], s95 offen sc1
    s_mov_b64 exec, 0xffff
    buffer_store_dword v20, v56, s[20:23], s95 offen offset:256 sc1
    s_mov_b64 exec, -1
cs_skipB0:
    s_waitcnt vmcnt(14)
    s_waitcnt lgkmcnt(0)
    s_barrier
    s_add_u32 m0, s43, 61440
    s_nop 0
    buffer_load_dwordx4 v2, s[12:15], s41 offen offset:0 lds
    s_add_u32 m0, s43, 65408
    s_nop 0
    buffer_load_dwordx4 v2, s[12:15], s41 offen offset:128 lds
    s_add_u32 m0, s43, 69632
    s_nop 0
    buffer_load_dwordx4 v3, s[16:19], s41 offen offset:0 lds
    s_add_u32 m0, s43, 73600
    s_nop 0
    buffer_load_dwordx4 v3, s[16:19], s41 offen offset:128 lds
    s_add_u32 m0, s43, 77824
    s_mov_b64 exec, s[54:55]
    buffer_load_dwordx4 v4, s[12:15], s41 offen lds
    s_mov_b64 exec, s[56:57]
    buffer_load_dwordx4 v5, s[16:19], s41 offen lds
    s_mov_b64 exec, -1
    s_add_u32 s41, s41, 114688
    s_cmp_eq_u32 s41, 1835008
    s_cselect_b32 s41, 0, s41
    s_add_u32 m0, s43, 81920
    s_nop 0
    buffer_load_dwordx4 v2, s[12:15], s41 offen offset:0 lds
    s_add_u32 m0, s43, 85888
    s_nop 0
    buffer_load_dwordx4 v2, s[12:15], s41 offen offset:128 lds
    s_add_u32 m0, s43, 90112
    s_nop 0
    buffer_load_dwordx4 v3, s[16:19], s41 offen offset:0 lds
    s_add_u32 m0, s43, 94080
    s_nop 0
    buffer_load_dwordx4 v3, s[16:19], s41 offen offset:128 lds
    s_add_u32 m0, s43, 98304
    s_mov_b64 exec, s[54:55]
    buffer_load_dwordx4 v4, s[12:15], s41 offen lds
    s_mov_b64 exec, s[56:57]
    buffer_load_dwordx4 v5, s[16:19], s41 offen lds
    s_mov_b64 exec, -1
    s_add_u32 s41, s41, 114688
    s_cmp_eq_u32 s41, 1835008
    s_cselect_b32 s41, 0, s41
    s_lshr_b32 s3, s50, 3
    s_cmp_lg_u32 s3, 1
    s_cbranch_scc1 cs_skipB1
    ds_read_b64_tr_b16 v[32:33], v9 offset:20480
    ds_read_b64_tr_b16 v[34:35], v9 offset:20992
    ds_read_b64_tr_b16 v[36:37], v9 offset:24576
    ds_read_b64_tr_b16 v[38:39], v9 offset:25088
    ds_read_b64_tr_b16 v[40:41], v9 offset:28672
    ds_read_b64_tr_b16 v[42:43], v9 offset:29184
    ds_read_b64_tr_b16 v[44:45], v9 offset:32768
    ds_read_b64_tr_b16 v[46:47], v9 offset:33280
    ds_read_b64_tr_b16 v[48:49], v9 offset:36864
    ds_read_b64_tr_b16 v[50:51], v9 offset:37376
    v_mov_b32 v16, 0
    v_mov_b32 v17, 0
    v_mov_b32 v18, 0
    v_mov_b32 v19, 0
    v_mov_b32 v20, 0
    v_lshlrev_b32 v56, 2, v0
    s_waitcnt lgkmcnt(0)
    v_dot2c_f32_bf16 v16, s53, v32
    v_dot2c_f32_bf16 v17, s53, v36
    v_dot2c_f32_bf16 v18, s53, v40
    v_dot2c_f32_bf16 v19, s53, v44
    v_dot2c_f32_bf16 v20, s53, v48
    v_dot2c_f32_bf16 v16, s53, v33
    v_dot2c_f32_bf16 v17, s53, v37
    v_dot2c_f32_bf16 v18, s53, v41
    v_dot2c_f32_bf16 v19, s53, v45
    v_dot2c_f32_bf16 v20, s53, v49
    v_dot2c_f32_bf16 v16, s53, v34
    v_dot2c_f32_bf16 v17, s53, v38
    v_dot2c_f32_bf16 v18, s53, v42
    v_dot2c_f32_bf16 v19, s53, v46
    v_dot2c_f32_bf16 v20, s53, v50
    v_dot2c_f32_bf16 v16, s53, v35
    v_dot2c_f32_bf16 v17, s53, v39
    v_dot2c_f32_bf16 v18, s53, v43
    v_dot2c_f32_bf16 v19, s53, v47
    v_dot2c_f32_bf16 v20, s53, v51
    s_nop 0
    v_permlane32_swap_b32 v16, v18
    v_permlane32_swap_b32 v17, v19
    v_mov_b32 v58, v20
    v_add_f32 v16, v16, v18
    v_add_f32 v17, v17, v19
    v_permlane32_swap_b32 v20, v58
    v_add_f32 v20, v20, v58
    v_permlane16_swap_b32 v16, v17
    v_mov_b32 v58, v20
    v_add_f32 v16, v16, v17
    s_nop 0
    v_permlane16_swap_b32 v20, v58
    v_add_f32 v20, v20, v58
    buffer_store_dword v16, v56, s[20:23], s95 offen sc1
    s_mov_b64 exec, 0xffff
    buffer_store_dword v20, v56, s[20:23], s95 offen offset:256 sc1
    s_mov_b64 exec, -1
cs_skipB1:
    s_waitcnt vmcnt(16)
    s_waitcnt lgkmcnt(0)
    s_barrier
    s_add_u32 m0, s43, 0
    s_nop 0
    buffer_load_dwordx4 v2, s[12:15], s41 offen offset:0 lds
    s_add_u32 m0, s43, 3968
    s_nop 0
    buffer_load_dwordx4 v2, s[12:15], s41 offen offset:128 lds
    s_add_u32 m0, s43, 8192
    s_nop 0
    buffer_load_dwordx4 v3, s[16:19], s41 offen offset:0 lds
    s_add_u32 m0, s43, 12160
    s_nop 0
    buffer_load_dwordx4 v3, s[16:19], s41 offen offset:128 lds
    s_add_u32 m0, s43, 16384
    s_mov_b64 exec, s[54:55]
    buffer_load_dwordx4 v4, s[12:15], s41 offen lds
    s_mov_b64 exec, s[56:57]
    buffer_load_dwordx4 v5, s[16:19], s41 offen lds
    s_mov_b64 exec, -1
    s_add_u32 s41, s41, 114688
    s_cmp_eq_u32 s41, 1835008
    s_cselect_b32 s41, 0, s41
    s_add_u32 m0, s44, 102400
    s_nop 0
    buffer_load_dwordx4 v6, s[4:7], s42 offen offset:0 lds
    s_add_u32 m0, s44, 103424
    s_nop 0
    buffer_load_dwordx4 v7, s[4:7], s42 offen offset:0 lds
    s_add_u32 m0, s44, 103424
    s_nop 0
    buffer_load_dwordx4 v6, s[4:7], s42 offen offset:1024 lds
    s_add_u32 m0, s44, 104448
    s_nop 0
    buffer_load_dwordx4 v7, s[4:7], s42 offen offset:1024 lds
    s_add_u32 s42, s42, 128
    s_and_b32 s42, s42, 1023
    s_waitcnt vmcnt(16)
    s_waitcnt lgkmcnt(0)
    s_barrier
    s_add_u32 m0, s43, 20480
    s_nop 0
    buffer_load_dwordx4 v2, s[12:15], s41 offen offset:0 lds
    s_add_u32 m0, s43, 24448
    s_nop 0
    buffer_load_dwordx4 v2, s[12:15], s41 offen offset:128 lds
    s_add_u32 m0, s43, 28672
    s_nop 0
    buffer_load_dwordx4 v3, s[16:19], s41 offen offset:0 lds
    s_add_u32 m0, s43, 32640
    s_nop 0
    buffer_load_dwordx4 v3, s[16:19], s41 offen offset:128 lds
    s_add_u32 m0, s43, 36864
    s_mov_b64 exec, s[54:55]
    buffer_load_dwordx4 v4, s[12:15], s41 offen lds
    s_mov_b64 exec, s[56:57]
    buffer_load_dwordx4 v5, s[16:19], s41 offen lds
    s_mov_b64 exec, -1
    s_add_u32 s41, s41, 114688
    s_cmp_eq_u32 s41, 1835008
    s_cselect_b32 s41, 0, s41
    buffer_load_dwordx2 v[60:61], v54, s[68:71], s90 offen offset:0
    buffer_load_dwordx2 v[62:63], v54, s[68:71], s90 offen offset:1024
    buffer_load_dwordx2 v[64:65], v54, s[68:71], s90 offen offset:2048
    buffer_load_dwordx2 v[66:67], v54, s[68:71], s90 offen offset:3072
    buffer_load_dwordx2 v[68:69], v52, s[28:31], s91 offen offset:0
    buffer_load_dwordx2 v[70:71], v52, s[28:31], s91 offen offset:1024
    buffer_load_dwordx2 v[72:73], v52, s[28:31], s91 offen offset:2048
    buffer_load_dwordx2 v[74:75], v52, s[28:31], s91 offen offset:3072
    s_waitcnt vmcnt(24)
    s_waitcnt lgkmcnt(0)
    s_barrier
    s_add_u32 m0, s43, 40960
    s_nop 0
    buffer_load_dwordx4 v2, s[12:15], s41 offen offset:0 lds
    s_add_u32 m0, s43, 44928
    s_nop 0
    buffer_load_dwordx4 v2, s[12:15], s41 offen offset:128 lds
    s_add_u32 m0, s43, 49152
    s_nop 0
    buffer_load_dwordx4 v3, s[16:19], s41 offen offset:0 lds
    s_add_u32 m0, s43, 53120
    s_nop 0
    buffer_load_dwordx4 v3, s[16:19], s41 offen offset:128 lds
    s_add_u32 m0, s43, 57344
    s_mov_b64 exec, s[54:55]
    buffer_load_dwordx4 v4, s[12:15], s41 offen lds
    s_mov_b64 exec, s[56:57]
    buffer_load_dwordx4 v5, s[16:19], s41 offen lds
    s_mov_b64 exec, -1
    s_add_u32 s41, s41, 114688
    s_cmp_eq_u32 s41, 1835008
    s_cselect_b32 s41, 0, s41
    s_add_u32 m0, s44, 120832
    s_nop 0
    buffer_load_dwordx4 v6, s[4:7], s42 offen offset:0 lds
    s_add_u32 m0, s44, 121856
    s_nop 0
    buffer_load_dwordx4 v7, s[4:7], s42 offen offset:0 lds
    s_add_u32 m0, s44, 121856
    s_nop 0
    buffer_load_dwordx4 v6, s[4:7], s42 offen offset:1024 lds
    s_add_u32 m0, s44, 122880
    s_nop 0
    buffer_load_dwordx4 v7, s[4:7], s42 offen offset:1024 lds
    s_add_u32 s42, s42, 128
    s_and_b32 s42, s42, 1023
    s_waitcnt vmcnt(14)
    s_mov_b32 s60, 0x05040100
    s_mov_b32 s61, 0x07060302
    v_perm_b32 v40, v62, v60, s60
    v_perm_b32 v42, v62, v60, s61
    v_perm_b32 v41, v66, v64, s60
    v_perm_b32 v43, v66, v64, s61
    v_perm_b32 v44, v63, v61, s60
    v_perm_b32 v46, v63, v61, s61
    v_perm_b32 v45, v67, v65, s60
    v_perm_b32 v47, v67, v65, s61
    v_permlane16_swap_b32 v40, v42
    v_permlane16_swap_b32 v41, v43
    v_permlane16_swap_b32 v44, v46
    v_permlane16_swap_b32 v45, v47
    buffer_store_dwordx4 v[40:43], v55, s[20:23], s92 offen sc1
    buffer_store_dwordx4 v[44:47], v55, s[20:23], s92 offen offset:1024 sc1
    s_waitcnt vmcnt(30)
    s_waitcnt lgkmcnt(0)
    s_barrier
    s_add_u32 m0, s43, 61440
    s_nop 0
    buffer_load_dwordx4 v2, s[12:15], s41 offen offset:0 lds
    s_add_u32 m0, s43, 65408
    s_nop 0
    buffer_load_dwordx4 v2, s[12:15], s41 offen offset:128 lds
    s_add_u32 m0, s43, 69632
    s_nop 0
    buffer_load_dwordx4 v3, s[16:19], s41 offen offset:0 lds
    s_add_u32 m0, s43, 73600
    s_nop 0
    buffer_load_dwordx4 v3, s[16:19], s41 offen offset:128 lds
    s_add_u32 m0, s43, 77824
    s_mov_b64 exec, s[54:55]
    buffer_load_dwordx4 v4, s[12:15], s41 offen lds
    s_mov_b64 exec, s[56:57]
    buffer_load_dwordx4 v5, s[16:19], s41 offen lds
    s_mov_b64 exec, -1
    s_add_u32 s41, s41, 114688
    s_cmp_eq_u32 s41, 1835008
    s_cselect_b32 s41, 0, s41
    s_waitcnt vmcnt(18)
    s_mov_b32 s60, 0x05040100
    s_mov_b32 s61, 0x07060302
    v_perm_b32 v40, v70, v68, s60
    v_perm_b32 v42, v70, v68, s61
    v_perm_b32 v41, v74, v72, s60
    v_perm_b32 v43, v74, v72, s61
    v_perm_b32 v44, v71, v69, s60
    v_perm_b32 v46, v71, v69, s61
    v_perm_b32 v45, v75, v73, s60
    v_perm_b32 v47, v75, v73, s61
    v_permlane16_swap_b32 v40, v42
    v_permlane16_swap_b32 v41, v43
    v_permlane16_swap_b32 v44, v46
    v_permlane16_swap_b32 v45, v47
    buffer_store_dwordx4 v[40:43], v53, s[20:23], s93 offen sc1
    buffer_store_dwordx4 v[44:47], v53, s[20:23], s93 offen offset:1024 sc1
    s_waitcnt vmcnt(28)
    s_waitcnt lgkmcnt(0)
    s_barrier
    s_add_u32 m0, s43, 81920
    s_nop 0
    buffer_load_dwordx4 v2, s[12:15], s41 offen offset:0 lds
    s_add_u32 m0, s43, 85888
    s_nop 0
    buffer_load_dwordx4 v2, s[12:15], s41 offen offset:128 lds
    s_add_u32 m0, s43, 90112
    s_nop 0
    buffer_load_dwordx4 v3, s[16:19], s41 offen offset:0 lds
    s_add_u32 m0, s43, 94080
    s_nop 0
    buffer_load_dwordx4 v3, s[16:19], s41 offen offset:128 lds
    s_add_u32 m0, s43, 98304
    s_mov_b64 exec, s[54:55]
    buffer_load_dwordx4 v4, s[12:15], s41 offen lds
    s_mov_b64 exec, s[56:57]
    buffer_load_dwordx4 v5, s[16:19], s41 offen lds
    s_mov_b64 exec, -1
    s_add_u32 s41, s41, 114688
    s_cmp_eq_u32 s41, 1835008
    s_cselect_b32 s41, 0, s41
    s_add_u32 m0, s44, 139264
    s_nop 0
    buffer_load_dwordx4 v6, s[4:7], s42 offen offset:0 lds
    s_add_u32 m0, s44, 140288
    s_nop 0
    buffer_load_dwordx4 v7, s[4:7], s42 offen offset:0 lds
    s_add_u32 m0, s44, 140288
    s_nop 0
    buffer_load_dwordx4 v6, s[4:7], s42 offen offset:1024 lds
    s_add_u32 m0, s44, 141312
    s_nop 0
    buffer_load_dwordx4 v7, s[4:7], s42 offen offset:1024 lds
    s_add_u32 s42, s42, 128
    s_and_b32 s42, s42, 1023
    s_waitcnt vmcnt(24)
    s_waitcnt lgkmcnt(0)
    s_barrier
    s_add_u32 m0, s43, 0
    s_nop 0
    buffer_load_dwordx4 v2, s[12:15], s41 offen offset:0 lds
    s_add_u32 m0, s43, 3968
    s_nop 0
    buffer_load_dwordx4 v2, s[12:15], s41 offen offset:128 lds
    s_add_u32 m0, s43, 8192
    s_nop 0
    buffer_load_dwordx4 v3, s[16:19], s41 offen offset:0 lds
    s_add_u32 m0, s43, 12160
    s_nop 0
    buffer_load_dwordx4 v3, s[16:19], s41 offen offset:128 lds
    s_add_u32 m0, s43, 16384
    s_mov_b64 exec, s[54:55]
    buffer_load_dwordx4 v4, s[12:15], s41 offen lds
    s_mov_b64 exec, s[56:57]
    buffer_load_dwordx4 v5, s[16:19], s41 offen lds
    s_mov_b64 exec, -1
    s_add_u32 s41, s41, 114688
    s_cmp_eq_u32 s41, 1835008
    s_cselect_b32 s41, 0, s41
    s_waitcnt vmcnt(16)
    s_waitcnt vmcnt(18)
    s_waitcnt lgkmcnt(0)
    s_barrier
    s_cmp_lg_u32 s47, 0
    s_cbranch_scc1 pf_skipB
    s_add_u32 s61, s76, 1
    s_mov_b64 exec, 7
    v_mov_b32 v58, s61
    buffer_store_dword v58, v21, s[20:23], 0 offen sc1
    s_mov_b64 exec, -1
pf_skipB:
    s_add_u32 m0, s43, 20480
    s_nop 0
    buffer_load_dwordx4 v2, s[12:15], s41 offen offset:0 lds
    s_add_u32 m0, s43, 24448
    s_nop 0
    buffer_load_dwordx4 v2, s[12:15], s41 offen offset:128 lds
    s_add_u32 m0, s43, 28672
    s_nop 0
    buffer_load_dwordx4 v3, s[16:19], s41 offen offset:0 lds
    s_add_u32 m0, s43, 32640
    s_nop 0
    buffer_load_dwordx4 v3, s[16:19], s41 offen offset:128 lds
    s_add_u32 m0, s43, 36864
    s_mov_b64 exec, s[54:55]
    buffer_load_dwordx4 v4, s[12:15], s41 offen lds
    s_mov_b64 exec, s[56:57]
    buffer_load_dwordx4 v5, s[16:19], s41 offen lds
    s_mov_b64 exec, -1
    s_add_u32 s41, s41, 114688
    s_cmp_eq_u32 s41, 1835008
    s_cselect_b32 s41, 0, s41
    s_add_u32 m0, s44, 102400
    s_nop 0
    buffer_load_dwordx4 v6, s[4:7], s42 offen offset:0 lds
    s_add_u32 m0, s44, 103424
    s_nop 0
    buffer_load_dwordx4 v7, s[4:7], s42 offen offset:0 lds
    s_add_u32 m0, s44, 103424
    s_nop 0
    buffer_load_dwordx4 v6, s[4:7], s42 offen offset:1024 lds
    s_add_u32 m0, s44, 104448
    s_nop 0
    buffer_load_dwordx4 v7, s[4:7], s42 offen offset:1024 lds
    s_add_u32 s42, s42, 128
    s_and_b32 s42, s42, 1023
    s_waitcnt vmcnt(20)
    s_waitcnt lgkmcnt(0)
    s_barrier
    s_add_u32 m0, s43, 40960
    s_nop 0
    buffer_load_dwordx4 v2, s[12:15], s41 offen offset:0 lds
    s_add_u32 m0, s43, 44928
    s_nop 0
    buffer_load_dwordx4 v2, s[12:15], s41 offen offset:128 lds
    s_add_u32 m0, s43, 49152
    s_nop 0
    buffer_load_dwordx4 v3, s[16:19], s41 offen offset:0 lds
    s_add_u32 m0, s43, 53120
    s_nop 0
    buffer_load_dwordx4 v3, s[16:19], s41 offen offset:128 lds
    s_add_u32 m0, s43, 57344
    s_mov_b64 exec, s[54:55]
    buffer_load_dwordx4 v4, s[12:15], s41 offen lds
    s_mov_b64 exec, s[56:57]
    buffer_load_dwordx4 v5, s[16:19], s41 offen lds
    s_mov_b64 exec, -1
    s_add_u32 s41, s41, 114688
    s_cmp_eq_u32 s41, 1835008
    s_cselect_b32 s41, 0, s41
    s_add_u32 m0, s43, 61440
    s_nop 0
    buffer_load_dwordx4 v2, s[12:15], s41 offen offset:0 lds
    s_add_u32 m0, s43, 65408
    s_nop 0
    buffer_load_dwordx4 v2, s[12:15], s41 offen offset:128 lds
    s_add_u32 m0, s43, 69632
    s_nop 0
    buffer_load_dwordx4 v3, s[16:19], s41 offen offset:0 lds
    s_add_u32 m0, s43, 73600
    s_nop 0
    buffer_load_dwordx4 v3, s[16:19], s41 offen offset:128 lds
    s_add_u32 m0, s43, 77824
    s_mov_b64 exec, s[54:55]
    buffer_load_dwordx4 v4, s[12:15], s41 offen lds
    s_mov_b64 exec, s[56:57]
    buffer_load_dwordx4 v5, s[16:19], s41 offen lds
    s_mov_b64 exec, -1
    s_add_u32 s41, s41, 114688
    s_cmp_eq_u32 s41, 1835008
    s_cselect_b32 s41, 0, s41
    s_waitcnt vmcnt(22)
    s_waitcnt lgkmcnt(0)
    s_barrier
    s_add_u32 m0, s43, 81920
    s_nop 0
    buffer_load_dwordx4 v2, s[12:15], s41 offen offset:0 lds
    s_add_u32 m0, s43, 85888
    s_nop 0
    buffer_load_dwordx4 v2, s[12:15], s41 offen offset:128 lds
    s_add_u32 m0, s43, 90112
    s_nop 0
    buffer_load_dwordx4 v3, s[16:19], s41 offen offset:0 lds
    s_add_u32 m0, s43, 94080
    s_nop 0
    buffer_load_dwordx4 v3, s[16:19], s41 offen offset:128 lds
    s_add_u32 m0, s43, 98304
    s_mov_b64 exec, s[54:55]
    buffer_load_dwordx4 v4, s[12:15], s41 offen lds
    s_mov_b64 exec, s[56:57]
    buffer_load_dwordx4 v5, s[16:19], s41 offen lds
    s_mov_b64 exec, -1
    s_add_u32 s41, s41, 114688
    s_cmp_eq_u32 s41, 1835008
    s_cselect_b32 s41, 0, s41
    s_add_u32 m0, s44, 120832
    s_nop 0
    buffer_load_dwordx4 v6, s[4:7], s42 offen offset:0 lds
    s_add_u32 m0, s44, 121856
    s_nop 0
    buffer_load_dwordx4 v7, s[4:7], s42 offen offset:0 lds
    s_add_u32 m0, s44, 121856
    s_nop 0
    buffer_load_dwordx4 v6, s[4:7], s42 offen offset:1024 lds
    s_add_u32 m0, s44, 122880
    s_nop 0
    buffer_load_dwordx4 v7, s[4:7], s42 offen offset:1024 lds
    s_waitcnt vmcnt(26)
    s_waitcnt lgkmcnt(0)
    s_barrier
    s_cmp_lg_u32 s47, 0
    s_cbranch_scc1 pl_skipB
    buffer_load_dwordx4 v[68:71], v13, s[20:23], 0 offen sc1
pl_skipB:
    s_add_u32 m0, s43, 0
    s_nop 0
    buffer_load_dwordx4 v2, s[12:15], s41 offen offset:0 lds
    s_add_u32 m0, s43, 3968
    s_nop 0
    buffer_load_dwordx4 v2, s[12:15], s41 offen offset:128 lds
    s_add_u32 m0, s43, 8192
    s_nop 0
    buffer_load_dwordx4 v3, s[16:19], s41 offen offset:0 lds
    s_add_u32 m0, s43, 12160
    s_nop 0
    buffer_load_dwordx4 v3, s[16:19], s41 offen offset:128 lds
    s_add_u32 m0, s43, 16384
    s_mov_b64 exec, s[54:55]
    buffer_load_dwordx4 v4, s[12:15], s41 offen lds
    s_mov_b64 exec, s[56:57]
    buffer_load_dwordx4 v5, s[16:19], s41 offen lds
    s_mov_b64 exec, -1
    s_cmp_lg_u32 s47, 0
    s_cbranch_scc1 pp_doneB
    s_mov_b32 s63, 0
    s_add_u32 s61, s76, 1
    s_waitcnt vmcnt(6)
pp_spinB:
    v_xor_b32 v58, s61, v68
    v_xor_b32 v59, s61, v69
    v_xor_b32 v60, s61, v70
    v_xor_b32 v61, s61, v71
    v_or_b32 v58, v58, v59
    v_or3_b32 v58, v58, v60, v61
    v_cmp_ne_u32 vcc, 0, v58
    s_cbranch_vccz pp_doneB
    s_add_u32 s63, s63, 1
    s_cmp_ge_u32 s63, 0x8000
    s_cbranch_scc1 pp_doneB
    s_sleep 4
    buffer_load_dwordx4 v[68:71], v13, s[20:23], 0 offen sc1
    s_waitcnt vmcnt(0)
    s_branch pp_spinB
pp_doneB:
    s_waitcnt vmcnt(22)
    s_waitcnt lgkmcnt(0)
    s_barrier
    buffer_load_dwordx2 v[56:57], v14, s[20:23], 0 offen sc1
    v_lshlrev_b32 v58, 2, v0
    v_lshrrev_b32 v59, 4, v0
    v_mul_u32_u24 v59, 1280, v59
    v_and_b32 v60, 15, v0
    v_lshlrev_b32 v60, 2, v60
    v_add_u32 v59, v59, v60
    s_add_u32 s3, s94, 0
    buffer_load_dword v32, v58, s[20:23], s3 offen offset:0 sc1
    buffer_load_dword v33, v58, s[20:23], s3 offen offset:1280 sc1
    buffer_load_dword v34, v58, s[20:23], s3 offen offset:2560 sc1
    s_add_u32 s3, s94, 3840
    buffer_load_dword v35, v58, s[20:23], s3 offen offset:0 sc1
    buffer_load_dword v36, v58, s[20:23], s3 offen offset:1280 sc1
    buffer_load_dword v37, v58, s[20:23], s3 offen offset:2560 sc1
    s_add_u32 s3, s94, 7680
    buffer_load_dword v38, v58, s[20:23], s3 offen offset:0 sc1
    buffer_load_dword v39, v58, s[20:23], s3 offen offset:1280 sc1
    buffer_load_dword v40, v58, s[20:23], s3 offen offset:2560 sc1
    s_add_u32 s3, s94, 11520
    buffer_load_dword v41, v58, s[20:23], s3 offen offset:0 sc1
    buffer_load_dword v42, v58, s[20:23], s3 offen offset:1280 sc1
    buffer_load_dword v43, v58, s[20:23], s3 offen offset:2560 sc1
    s_add_u32 s3, s94, 15360
    buffer_load_dword v44, v58, s[20:23], s3 offen offset:0 sc1
    buffer_load_dword v45, v58, s[20:23], s3 offen offset:1280 sc1
    buffer_load_dword v46, v58, s[20:23], s3 offen offset:2560 sc1
    s_add_u32 s3, s94, 19200
    buffer_load_dword v47, v58, s[20:23], s3 offen offset:0 sc1
    s_add_u32 s3, s94, 0
    buffer_load_dword v48, v59, s[20:23], s3 offen offset:256 sc1
    s_add_u32 s3, s94, 5120
    buffer_load_dword v49, v59, s[20:23], s3 offen offset:256 sc1
    s_add_u32 s3, s94, 10240
    buffer_load_dword v50, v59, s[20:23], s3 offen offset:256 sc1
    s_add_u32 s3, s94, 15360
    buffer_load_dword v51, v59, s[20:23], s3 offen offset:256 sc1
    s_bfe_u32 s89, s96, 0x40000
    s_lshl_b32 s89, s89, 11
    s_add_u32 s89, s89, s80
    buffer_load_dwordx4 v[176:179], v55, s[20:23], s89 offen offset:0 sc1
    buffer_load_dwordx4 v[180:183], v55, s[20:23], s89 offen offset:1024 sc1
    s_bfe_u32 s89, s96, 0x40004
    s_lshl_b32 s89, s89, 11
    s_add_u32 s89, s89, s80
    buffer_load_dwordx4 v[184:187], v55, s[20:23], s89 offen offset:0 sc1
    buffer_load_dwordx4 v[188:191], v55, s[20:23], s89 offen offset:1024 sc1
    s_waitcnt vmcnt(41)
    s_waitcnt lgkmcnt(0)
    s_barrier
    s_bfe_u32 s89, s96, 0x40008
    s_lshl_b32 s89, s89, 11
    s_add_u32 s89, s89, s80
    buffer_load_dwordx4 v[112:115], v55, s[20:23], s89 offen offset:0 sc1
    buffer_load_dwordx4 v[116:119], v55, s[20:23], s89 offen offset:1024 sc1
    s_bfe_u32 s89, s96, 0x4000c
    s_lshl_b32 s89, s89, 11
    s_add_u32 s89, s89, s80
    buffer_load_dwordx4 v[120:123], v55, s[20:23], s89 offen offset:0 sc1
    buffer_load_dwordx4 v[124:127], v55, s[20:23], s89 offen offset:1024 sc1
    s_bfe_u32 s89, s96, 0x40010
    s_lshl_b32 s89, s89, 11
    s_add_u32 s89, s89, s80
    buffer_load_dwordx4 v[192:195], v55, s[20:23], s89 offen offset:0 sc1
    buffer_load_dwordx4 v[196:199], v55, s[20:23], s89 offen offset:1024 sc1
    s_bfe_u32 s89, s96, 0x40014
    s_lshl_b32 s89, s89, 11
    s_add_u32 s89, s89, s80
    buffer_load_dwordx4 v[200:203], v55, s[20:23], s89 offen offset:0 sc1
    buffer_load_dwordx4 v[204:207], v55, s[20:23], s89 offen offset:1024 sc1
    s_waitcnt vmcnt(32)
    ds_write_b64 v15, v[56:57]
    s_waitcnt vmcnt(12)
    v_pk_add_f32 v[32:33], v[32:33], v[40:41]
    v_pk_add_f32 v[34:35], v[34:35], v[42:43]
    v_pk_add_f32 v[36:37], v[36:37], v[44:45]
    v_pk_add_f32 v[38:39], v[38:39], v[46:47]
    v_pk_add_f32 v[48:49], v[48:49], v[50:51]
    v_pk_add_f32 v[32:33], v[32:33], v[36:37]
    v_pk_add_f32 v[34:35], v[34:35], v[38:39]
    v_add_f32 v20, v48, v49
    v_pk_add_f32 v[32:33], v[32:33], v[34:35]
    v_mov_b32 v58, v20
    v_add_f32 v16, v32, v33
    s_nop 0
    v_permlane32_swap_b32 v20, v58
    v_add_f32 v20, v20, v58
    v_mov_b32 v58, v20
    s_nop 1
    v_permlane16_swap_b32 v20, v58
    v_add_f32 v20, v20, v58
    v_cvt_pk_bf16_f32 v60, v16, v16
    v_and_b32 v62, 0xffff0000, v60
    v_sub_f32 v16, v16, v62
    v_cvt_pk_bf16_f32 v63, v16, v16
    v_and_b32 v62, 0xffff0000, v63
    v_sub_f32 v16, v16, v62
    v_cvt_pk_bf16_f32 v61, v16, v16
    v_and_b32 v60, 0xffff, v60
    v_or_b32 v60, v60, v62
    v_and_b32 v61, 0xffff, v61
    v_cvt_pk_bf16_f32 v66, v20, v20
    v_and_b32 v68, 0xffff0000, v66
    v_sub_f32 v20, v20, v68
    v_cvt_pk_bf16_f32 v69, v20, v20
    v_and_b32 v68, 0xffff0000, v69
    v_sub_f32 v20, v20, v68
    v_cvt_pk_bf16_f32 v67, v20, v20
    v_and_b32 v66, 0xffff, v66
    v_or_b32 v66, v66, v68
    v_and_b32 v67, 0xffff, v67
    v_and_b32 v58, 15, v0
    v_lshlrev_b32 v58, 3, v58
    s_lshl_b32 s3, s47, 7
    s_add_u32 s3, s3, 157696
    v_add_u32 v103, s3, v58
    v_lshrrev_b32 v59, 4, v0
    v_lshlrev_b32 v59, 9, v59
    v_add_u32 v59, v59, v103
    ds_write_b64 v59, v[60:61]
    ds_write_b64 v103, v[66:67] offset:2048
    s_waitcnt lgkmcnt(0)
    s_waitcnt vmcnt(39)
    s_waitcnt lgkmcnt(0)
    s_barrier
    s_bfe_u32 s89, s96, 0x40018
    s_lshl_b32 s89, s89, 11
    s_add_u32 s89, s89, s80
    buffer_load_dwordx4 v[128:131], v55, s[20:23], s89 offen offset:0 sc1
    buffer_load_dwordx4 v[132:135], v55, s[20:23], s89 offen offset:1024 sc1
    s_bfe_u32 s89, s96, 0x4001c
    s_lshl_b32 s89, s89, 11
    s_add_u32 s89, s89, s80
    buffer_load_dwordx4 v[136:139], v55, s[20:23], s89 offen offset:0 sc1
    buffer_load_dwordx4 v[140:143], v55, s[20:23], s89 offen offset:1024 sc1
    s_bfe_u32 s89, s97, 0x40000
    s_lshl_b32 s89, s89, 11
    s_add_u32 s89, s89, s80
    buffer_load_dwordx4 v[208:211], v55, s[20:23], s89 offen offset:0 sc1
    buffer_load_dwordx4 v[212:215], v55, s[20:23], s89 offen offset:1024 sc1
    s_bfe_u32 s89, s97, 0x40004
    s_lshl_b32 s89, s89, 11
    s_add_u32 s89, s89, s80
    buffer_load_dwordx4 v[216:219], v55, s[20:23], s89 offen offset:0 sc1
    buffer_load_dwordx4 v[220:223], v55, s[20:23], s89 offen offset:1024 sc1
    s_waitcnt vmcnt(41)
    s_waitcnt lgkmcnt(0)
    s_barrier
    s_bfe_u32 s89, s98, 0x80000
    s_lshl_b32 s89, s89, 11
    s_add_u32 s89, s89, s82
    buffer_load_dwordx4 v[144:147], v55, s[20:23], s89 offen offset:0 sc1
    buffer_load_dwordx4 v[148:151], v55, s[20:23], s89 offen offset:1024 sc1
    s_bfe_u32 s89, s98, 0x80008
    s_lshl_b32 s89, s89, 11
    s_add_u32 s89, s89, s82
    buffer_load_dwordx4 v[152:155], v55, s[20:23], s89 offen offset:0 sc1
    buffer_load_dwordx4 v[156:159], v55, s[20:23], s89 offen offset:1024 sc1
    s_bfe_u32 s89, s98, 0x80010
    s_lshl_b32 s89, s89, 11
    s_add_u32 s89, s89, s82
    buffer_load_dwordx4 v[224:227], v55, s[20:23], s89 offen offset:0 sc1
    buffer_load_dwordx4 v[228:231], v55, s[20:23], s89 offen offset:1024 sc1
    s_bfe_u32 s89, s98, 0x80018
    s_lshl_b32 s89, s89, 11
    s_add_u32 s89, s89, s82
    buffer_load_dwordx4 v[232:235], v55, s[20:23], s89 offen offset:0 sc1
    buffer_load_dwordx4 v[236:239], v55, s[20:23], s89 offen offset:1024 sc1
    s_waitcnt lgkmcnt(0)
    s_barrier
    s_bfe_u32 s89, s99, 0x80000
    s_lshl_b32 s89, s89, 11
    s_add_u32 s89, s89, s82
    buffer_load_dwordx4 v[160:163], v55, s[20:23], s89 offen offset:0 sc1
    buffer_load_dwordx4 v[164:167], v55, s[20:23], s89 offen offset:1024 sc1
    s_bfe_u32 s89, s99, 0x80008
    s_lshl_b32 s89, s89, 11
    s_add_u32 s89, s89, s82
    buffer_load_dwordx4 v[168:171], v55, s[20:23], s89 offen offset:0 sc1
    buffer_load_dwordx4 v[172:175], v55, s[20:23], s89 offen offset:1024 sc1
    s_bfe_u32 s89, s99, 0x80010
    s_lshl_b32 s89, s89, 11
    s_add_u32 s89, s89, s82
    buffer_load_dwordx4 v[240:243], v55, s[20:23], s89 offen offset:0 sc1
    buffer_load_dwordx4 v[244:247], v55, s[20:23], s89 offen offset:1024 sc1
    s_bfe_u32 s89, s99, 0x80018
    s_lshl_b32 s89, s89, 11
    s_add_u32 s89, s89, s82
    buffer_load_dwordx4 v[248:251], v55, s[20:23], s89 offen offset:0 sc1
    buffer_load_dwordx4 v[252:255], v55, s[20:23], s89 offen offset:1024 sc1
    s_setprio 0
    s_branch pub
cons:
    s_getpc_b64 s[60:61]
pf_base:
    s_lshl_b32 s3, s46, 14
    v_lshlrev_b32 v88, 7, v0
    v_add_u32 v88, s3, v88
    v_add_u32 v90, 0x2000, v88
    v_min_u32 v88, k1_done - pf_base, v88
    v_min_u32 v90, k1_done - pf_base, v90
    v_mov_b32 v89, s61
    v_mov_b32 v91, s61
    v_add_co_u32 v88, vcc, s60, v88
    s_nop 1
    v_addc_co_u32 v89, vcc, 0, v89, vcc
    v_add_co_u32 v90, vcc, s60, v90
    s_nop 1
    v_addc_co_u32 v91, vcc, 0, v91, vcc
    global_load_dword v92, v[88:89], off
    global_load_dword v93, v[90:91], off
    s_lshl_b32 s60, s50, 7
    s_lshl_b32 s61, s52, 3
    s_add_u32 s60, s60, s61
    s_lshl_b32 s61, s47, 1
    s_add_u32 s60, s60, s61
    v_lshrrev_b32 v32, 5, v0
    v_lshlrev_b32 v32, 10, v32
    v_and_b32 v33, 31, v0
    v_lshlrev_b32 v33, 4, v33
    v_add_u32 v32, v32, v33
    s_lshr_b32 s45, s60, 5
    s_lshl_b32 s45, s45, 5
    s_and_b32 s61, s60, 31
    s_lshr_b32 s61, s61, 1
    s_add_u32 s45, s45, s61
    s_lshl_b32 s45, s45, 3
    s_lshl_b32 s44, s60, 10
    s_waitcnt lgkmcnt(0)
    s_mov_b64 s[4:5], s[76:77]
    s_mov_b64 s[8:9], s[78:79]
    s_mov_b64 s[12:13], s[84:85]
    s_mov_b64 s[16:17], s[86:87]
    s_mov_b64 s[20:21], s[94:95]
    s_mov_b64 s[24:25], s[92:93]
    s_mov_b64 s[28:29], s[88:89]
    s_mov_b64 s[32:33], s[80:81]
    s_mov_b64 s[36:37], s[90:91]
    buffer_load_dwordx4 v[24:27], v32, s[4:7], s44 offen
    buffer_load_dwordx4 v[28:31], v32, s[4:7], s44 offen offset:512
    s_load_dword s76, s[20:21], 16384
    s_lshr_b32 s49, s47, 1
    s_and_b32 s47, s47, 1
    s_cmp_lg_u32 s48, 0
    s_cbranch_scc1 cs_B
    s_lshl_b32 s83, s49, 6
    s_mov_b32 s84, 32
    s_add_u32 s85, s83, 4096
    s_mov_b32 s86, 32
    s_add_u32 s87, s83, 8192
    s_mov_b32 s88, 32
    s_add_u32 s89, s83, 12288
    s_mov_b32 s90, 4128
    s_add_u32 s91, s83, 12320
    s_mov_b32 s92, 4064
    s_lshl_b32 s66, s51, 2
    s_lshl_b32 s3, s49, 1
    s_add_u32 s66, s66, s3
    s_add_u32 s66, s66, 32
    s_add_u32 s67, s66, 1
    s_branch cs_D
cs_B:
    s_lshr_b32 s60, s72, 4
    s_add_u32 s60, s60, 32
    s_lshr_b32 s61, s73, 4
    s_add_u32 s61, s61, 32
    s_cmp_lg_u32 s49, 0
    s_cbranch_scc1 cs_B1
    s_mov_b32 s83, 0
    s_mov_b32 s84, 8224
    s_mov_b32 s85, 32
    s_mov_b32 s86, 8160
    s_mov_b32 s87, 64
    s_mov_b32 s88, 8224
    s_mov_b32 s89, 96
    s_mov_b32 s90, 8160
    s_mov_b32 s91, 4096
    s_mov_b32 s92, 8224
    s_mov_b32 s63, s60
    s_add_u32 s64, s60, 1
    s_add_u32 s65, s60, 2
    s_add_u32 s66, s60, 3
    s_add_u32 s67, s60, 4
    s_branch cs_D
cs_B1:
    s_mov_b32 s83, 4128
    s_mov_b32 s84, 8160
    s_mov_b32 s85, 4160
    s_mov_b32 s86, 8224
    s_mov_b32 s87, 4192
    s_mov_b32 s88, 8160
    s_mov_b32 s89, 16384
    s_mov_b32 s90, 96
    s_mov_b32 s91, 16416
    s_mov_b32 s92, 32
    s_add_u32 s63, s60, 5
    s_add_u32 s64, s60, 6
    s_add_u32 s65, s60, 7
    s_mov_b32 s66, s61
    s_add_u32 s67, s61, 1
cs_D:
    v_lshrrev_b32 v32, 5, v0
    v_bfe_u32 v33, v0, 2, 2
    v_lshlrev_b32 v34, 3, v32
    v_add_u32 v34, v34, v33
    v_lshlrev_b32 v34, 7, v34
    v_and_b32 v35, 3, v0
    v_lshlrev_b32 v35, 3, v35
    v_add_u32 v34, v34, v35
    v_and_b32 v35, 2, v33
    v_xor_b32 v35, v35, v32
    v_lshlrev_b32 v35, 5, v35
    v_bfe_u32 v36, v0, 4, 1
    v_and_b32 v37, 15, v0
    v_lshlrev_b32 v37, 3, v37
    v_add_u32 v37, 157696, v37
    v_mul_lo_u32 v38, v36, s84
    v_add_u32 v38, s83, v38
    v_xor_b32 v39, v38, v35
    v_add_u32 v2, v39, v34
    v_lshrrev_b32 v39, 12, v38
    v_lshlrev_b32 v39, 9, v39
    v_and_b32 v38, 0x60, v38
    v_lshlrev_b32 v38, 2, v38
    v_add_u32 v38, v38, v39
    v_add_u32 v16, v38, v37
    v_mul_lo_u32 v38, v36, s86
    v_add_u32 v38, s85, v38
    v_xor_b32 v39, v38, v35
    v_add_u32 v3, v39, v34
    v_lshrrev_b32 v39, 12, v38
    v_lshlrev_b32 v39, 9, v39
    v_and_b32 v38, 0x60, v38
    v_lshlrev_b32 v38, 2, v38
    v_add_u32 v38, v38, v39
    v_add_u32 v17, v38, v37
    v_mul_lo_u32 v38, v36, s88
    v_add_u32 v38, s87, v38
    v_xor_b32 v39, v38, v35
    v_add_u32 v4, v39, v34
    v_lshrrev_b32 v39, 12, v38
    v_lshlrev_b32 v39, 9, v39
    v_and_b32 v38, 0x60, v38
    v_lshlrev_b32 v38, 2, v38
    v_add_u32 v38, v38, v39
    v_add_u32 v18, v38, v37
    v_mul_lo_u32 v38, v36, s90
    v_add_u32 v38, s89, v38
    v_xor_b32 v39, v38, v35
    v_add_u32 v5, v39, v34
    v_lshrrev_b32 v39, 12, v38
    v_lshlrev_b32 v39, 9, v39
    v_and_b32 v38, 0x60, v38
    v_lshlrev_b32 v38, 2, v38
    v_add_u32 v38, v38, v39
    v_add_u32 v19, v38, v37
    v_mul_lo_u32 v38, v36, s92
    v_add_u32 v38, s91, v38
    v_xor_b32 v39, v38, v35
    v_add_u32 v6, v39, v34
    v_lshrrev_b32 v39, 12, v38
    v_lshlrev_b32 v39, 9, v39
    v_and_b32 v38, 0x60, v38
    v_lshlrev_b32 v38, 2, v38
    v_add_u32 v38, v38, v39
    v_add_u32 v20, v38, v37
    v_and_b32 v33, 31, v0
    s_lshl_b32 s3, s47, 6
    v_add_u32 v33, s3, v33
    v_lshlrev_b32 v21, 3, v33
    v_add_u32 v21, 160256, v21
    v_bfe_u32 v34, v33, 1, 3
    v_xor_b32 v34, v34, v32
    v_lshlrev_b32 v34, 4, v34
    v_lshlrev_b32 v33, 7, v33
    v_add_u32 v33, v33, v34
    v_add_u32 v12, 102400, v33
    v_xor_b32 v13, 32, v12
    v_xor_b32 v14, 64, v12
    v_xor_b32 v15, 96, v12
    v_lshlrev_b32 v22, 4, v0
    s_and_b32 s60, s2, 7
    s_lshr_b32 s61, s2, 3
    s_lshr_b32 s77, s61, 2
    s_lshl_b32 s78, s60, 2
    s_and_b32 s62, s61, 3
    s_add_u32 s78, s78, s62
    s_xor_b32 s79, s77, s78
    s_and_b32 s79, s79, 1
    s_lshl_b32 s79, s79, 2
    s_add_u32 s79, s79, s46
    s_and_b32 s79, s79, 7
    s_mul_i32 s60, s77, 144
    s_mul_i32 s61, s79, 10
    s_add_u32 s61, s61, 64
    s_lshl_b32 s62, s79, 2
    s_add_u32 s80, s60, s61
    s_lshl_b32 s80, s80, 11
    s_add_u32 s80, s80, 9830400
    s_add_u32 s82, s60, s62
    s_lshl_b32 s82, s82, 11
    s_add_u32 s82, s82, 9830400
    s_add_u32 s81, s82, 65536
    s_mul_i32 s60, s78, 288
    s_add_u32 s84, s60, s61
    s_lshl_b32 s84, s84, 10
    s_add_u32 s84, s84, 65536
    s_add_u32 s86, s60, s62
    s_lshl_b32 s86, s86, 10
    s_add_u32 s86, s86, 65536
    s_add_u32 s85, s86, 32768
    s_lshr_b32 s60, s78, 1
    s_lshl_b32 s60, s60, 4
    s_add_u32 s88, s60, s79
    s_lshl_b32 s88, s88, 7
    s_add_u32 s88, s88, 28672
    s_add_u32 s87, s88, 1024
    s_lshr_b32 s60, s77, 1
    s_and_b32 s61, s78, 2
    s_add_u32 s60, s60, s61
    s_and_b32 s60, s60, 3
    s_mul_i32 s61, s60, 5
    s_add_u32 s61, s61, 1
    s_lshr_b32 s61, s61, 1
    s_lshl_b32 s61, s61, 2
    s_mov_b32 s96, 0x76543210
    s_mov_b32 s97, 0x98
    s_sub_u32 s62, 40, s61
    s_lshl_b64 s[98:99], s[96:97], s62
    s_lshr_b64 s[96:97], s[96:97], s61
    s_or_b64 s[96:97], s[96:97], s[98:99]
    s_lshl_b32 s3, s60, 4
    s_and_b32 s61, s77, 1
    s_lshl_b32 s61, s61, 3
    s_add_u32 s3, s3, s61
    s_mov_b32 s98, 0x23222120
    s_mov_b32 s99, 0x03020100
    s_sub_u32 s62, 64, s3
    s_lshl_b64 s[60:61], s[98:99], s62
    s_lshr_b64 s[98:99], s[98:99], s3
    s_or_b64 s[98:99], s[98:99], s[60:61]
    s_waitcnt vmcnt(0)
    v_lshlrev_b32 v32, 16, v24
    v_and_b32 v24, 0xffff0000, v24
    v_lshlrev_b32 v33, 16, v25
    v_and_b32 v25, 0xffff0000, v25
    v_lshlrev_b32 v34, 16, v26
    v_and_b32 v26, 0xffff0000, v26
    v_lshlrev_b32 v35, 16, v27
    v_and_b32 v27, 0xffff0000, v27
    v_lshlrev_b32 v36, 16, v28
    v_and_b32 v28, 0xffff0000, v28
    v_lshlrev_b32 v37, 16, v29
    v_and_b32 v29, 0xffff0000, v29
    v_lshlrev_b32 v38, 16, v30
    v_and_b32 v30, 0xffff0000, v30
    v_lshlrev_b32 v39, 16, v31
    v_and_b32 v31, 0xffff0000, v31
    v_pk_add_f32 v[40:41], v[32:33], v[34:35]
    v_pk_add_f32 v[42:43], v[36:37], v[38:39]
    v_pk_add_f32 v[44:45], v[24:25], v[26:27]
    v_pk_add_f32 v[46:47], v[28:29], v[30:31]
    v_pk_add_f32 v[40:41], v[40:41], v[42:43]
    v_pk_add_f32 v[44:45], v[44:45], v[46:47]
    v_pk_add_f32 v[40:41], v[40:41], v[44:45]
    v_add_f32 v40, v40, v41
    s_nop 1
    v_add_f32_dpp v40, v40, v40 quad_perm:[1,0,3,2] row_mask:0xf bank_mask:0xf
    s_nop 1
    v_add_f32_dpp v40, v40, v40 quad_perm:[2,3,0,1] row_mask:0xf bank_mask:0xf
    s_nop 1
    v_add_f32_dpp v40, v40, v40 row_half_mirror row_mask:0xf bank_mask:0xf
    s_nop 1
    v_add_f32_dpp v40, v40, v40 row_mirror row_mask:0xf bank_mask:0xf
    v_mov_b32 v42, v40
    s_nop 1
    v_permlane16_swap_b32 v40, v42
    v_add_f32 v40, v40, v42
    v_mul_f32 v40, 0x3b000000, v40
    v_pk_add_f32 v[32:33], v[32:33], v[40:41] op_sel:[0,0] op_sel_hi:[1,0] neg_lo:[0,1] neg_hi:[0,1]
    v_pk_add_f32 v[34:35], v[34:35], v[40:41] op_sel:[0,0] op_sel_hi:[1,0] neg_lo:[0,1] neg_hi:[0,1]
    v_pk_add_f32 v[36:37], v[36:37], v[40:41] op_sel:[0,0] op_sel_hi:[1,0] neg_lo:[0,1] neg_hi:[0,1]
    v_pk_add_f32 v[38:39], v[38:39], v[40:41] op_sel:[0,0] op_sel_hi:[1,0] neg_lo:[0,1] neg_hi:[0,1]
    v_pk_add_f32 v[24:25], v[24:25], v[40:41] op_sel:[0,0] op_sel_hi:[1,0] neg_lo:[0,1] neg_hi:[0,1]
    v_pk_add_f32 v[26:27], v[26:27], v[40:41] op_sel:[0,0] op_sel_hi:[1,0] neg_lo:[0,1] neg_hi:[0,1]
    v_pk_add_f32 v[28:29], v[28:29], v[40:41] op_sel:[0,0] op_sel_hi:[1,0] neg_lo:[0,1] neg_hi:[0,1]
    v_pk_add_f32 v[30:31], v[30:31], v[40:41] op_sel:[0,0] op_sel_hi:[1,0] neg_lo:[0,1] neg_hi:[0,1]
    v_pk_mul_f32 v[42:43], v[32:33], v[32:33]
    v_pk_mul_f32 v[44:45], v[34:35], v[34:35]
    v_pk_fma_f32 v[42:43], v[36:37], v[36:37], v[42:43]
    v_pk_fma_f32 v[44:45], v[38:39], v[38:39], v[44:45]
    v_pk_fma_f32 v[42:43], v[24:25], v[24:25], v[42:43]
    v_pk_fma_f32 v[44:45], v[26:27], v[26:27], v[44:45]
    v_pk_fma_f32 v[42:43], v[28:29], v[28:29], v[42:43]
    v_pk_fma_f32 v[44:45], v[30:31], v[30:31], v[44:45]
    v_pk_add_f32 v[42:43], v[42:43], v[44:45]
    v_add_f32 v42, v42, v43
    s_nop 1
    v_add_f32_dpp v42, v42, v42 quad_perm:[1,0,3,2] row_mask:0xf bank_mask:0xf
    s_nop 1
    v_add_f32_dpp v42, v42, v42 quad_perm:[2,3,0,1] row_mask:0xf bank_mask:0xf
    s_nop 1
    v_add_f32_dpp v42, v42, v42 row_half_mirror row_mask:0xf bank_mask:0xf
    s_nop 1
    v_add_f32_dpp v42, v42, v42 row_mirror row_mask:0xf bank_mask:0xf
    v_mov_b32 v44, v42
    s_nop 1
    v_permlane16_swap_b32 v42, v44
    v_add_f32 v42, v42, v44
    v_mul_f32 v89, 0x3b000000, v42
    v_cvt_pk_bf16_f32 v88, v40, v40
    v_cvt_pk_bf16_f32 v89, v89, v89
    v_xor_b32 v88, 0x80008000, v88
    v_and_b32 v89, 0xffff0000, v89
    v_add_f32 v89, 0x3727c5ac, v89
    v_cvt_pk_bf16_f32 v89, v89, v89
    v_and_b32 v89, 0xffff0000, v89
    v_sqrt_f32 v89, v89
    v_lshrrev_b32 v90, 5, v0
    v_lshlrev_b32 v90, 7, v90
    v_cvt_pk_bf16_f32 v89, v89, v89
    v_and_b32 v89, 0xffff0000, v89
    v_rcp_f32 v89, v89
    s_mov_b32 exec_lo, 1
    s_mov_b32 exec_hi, 1
    buffer_store_dwordx2 v[88:89], v90, s[20:23], s45 offen sc1
    s_mov_b64 exec, -1
    v_mov_b32 v90, 0
    v_mov_b32 v91, 0
    v_mov_b32 v94, 0
    v_mov_b32 v95, 0
    s_barrier
    s_setprio 2
    ds_read_b128 v[52:55], v12 offset:0
    ds_read_b64_tr_b16 v[32:33], v2 offset:0
    ds_read_b64_tr_b16 v[34:35], v2 offset:512
    ds_read_b128 v[56:59], v12 offset:4096
    ds_read_b64_tr_b16 v[36:37], v3 offset:0
    ds_read_b64_tr_b16 v[38:39], v3 offset:512
    ds_read_b64_tr_b16 v[40:41], v4 offset:0
    ds_read_b64_tr_b16 v[42:43], v4 offset:512
    ds_read_b64_tr_b16 v[44:45], v5 offset:0
    ds_read_b64_tr_b16 v[46:47], v5 offset:512
    ds_read_b64_tr_b16 v[48:49], v6 offset:0
    ds_read_b64_tr_b16 v[50:51], v6 offset:512
    s_waitcnt lgkmcnt(0)
    v_mfma_f32_32x32x16_bf16 v[96:111], v[32:35], v[52:55], 0
    ds_read_b128 v[80:83], v13 offset:0
    ds_read_b64_tr_b16 v[60:61], v2 offset:2048
    v_mfma_f32_32x32x16_bf16 v[176:191], v[32:35], v[56:59], 0
    ds_read_b64_tr_b16 v[62:63], v2 offset:2560
    ds_read_b128 v[84:87], v13 offset:4096
    v_mfma_f32_32x32x16_bf16 v[112:127], v[36:39], v[52:55], 0
    ds_read_b64_tr_b16 v[64:65], v3 offset:2048
    ds_read_b64_tr_b16 v[66:67], v3 offset:2560
    v_mfma_f32_32x32x16_bf16 v[192:207], v[36:39], v[56:59], 0
    ds_read_b64_tr_b16 v[68:69], v4 offset:2048
    ds_read_b64_tr_b16 v[70:71], v4 offset:2560
    v_mfma_f32_32x32x16_bf16 v[128:143], v[40:43], v[52:55], 0
    ds_read_b64_tr_b16 v[72:73], v5 offset:2048
    ds_read_b64_tr_b16 v[74:75], v5 offset:2560
    v_mfma_f32_32x32x16_bf16 v[208:223], v[40:43], v[56:59], 0
    ds_read_b64_tr_b16 v[76:77], v6 offset:2048
    ds_read_b64_tr_b16 v[78:79], v6 offset:2560
    v_mfma_f32_32x32x16_bf16 v[144:159], v[44:47], v[52:55], 0
    v_mfma_f32_32x32x16_bf16 v[224:239], v[44:47], v[56:59], 0
    v_mfma_f32_32x32x16_bf16 v[160:175], v[48:51], v[52:55], 0
    v_mfma_f32_32x32x16_bf16 v[240:255], v[48:51], v[56:59], 0
    s_waitcnt lgkmcnt(0)
    v_mfma_f32_32x32x16_bf16 v[96:111], v[60:63], v[80:83], v[96:111]
    s_barrier
    ds_read_b128 v[52:55], v14 offset:0
    ds_read_b64_tr_b16 v[32:33], v2 offset:20480
    v_mfma_f32_32x32x16_bf16 v[176:191], v[60:63], v[84:87], v[176:191]
    ds_read_b64_tr_b16 v[34:35], v2 offset:20992
    ds_read_b128 v[56:59], v14 offset:4096
    v_mfma_f32_32x32x16_bf16 v[112:127], v[64:67], v[80:83], v[112:127]
    ds_read_b64_tr_b16 v[36:37], v3 offset:20480
    ds_read_b64_tr_b16 v[38:39], v3 offset:20992
    v_mfma_f32_32x32x16_bf16 v[192:207], v[64:67], v[84:87], v[192:207]
    ds_read_b64_tr_b16 v[40:41], v4 offset:20480
    ds_read_b64_tr_b16 v[42:43], v4 offset:20992
    v_mfma_f32_32x32x16_bf16 v[128:143], v[68:71], v[80:83], v[128:143]
    ds_read_b64_tr_b16 v[44:45], v5 offset:20480
    ds_read_b64_tr_b16 v[46:47], v5 offset:20992
    v_mfma_f32_32x32x16_bf16 v[208:223], v[68:71], v[84:87], v[208:223]
    ds_read_b64_tr_b16 v[48:49], v6 offset:20480
    ds_read_b64_tr_b16 v[50:51], v6 offset:20992
    v_mfma_f32_32x32x16_bf16 v[144:159], v[72:75], v[80:83], v[144:159]
    v_mfma_f32_32x32x16_bf16 v[224:239], v[72:75], v[84:87], v[224:239]
    v_mfma_f32_32x32x16_bf16 v[160:175], v[76:79], v[80:83], v[160:175]
    v_mfma_f32_32x32x16_bf16 v[240:255], v[76:79], v[84:87], v[240:255]
    s_waitcnt lgkmcnt(0)
    v_mfma_f32_32x32x16_bf16 v[96:111], v[32:35], v[52:55], v[96:111]
    ds_read_b128 v[80:83], v15 offset:0
    ds_read_b64_tr_b16 v[60:61], v2 offset:22528
    v_mfma_f32_32x32x16_bf16 v[176:191], v[32:35], v[56:59], v[176:191]
    ds_read_b64_tr_b16 v[62:63], v2 offset:23040
    ds_read_b128 v[84:87], v15 offset:4096
    v_mfma_f32_32x32x16_bf16 v[112:127], v[36:39], v[52:55], v[112:127]
    ds_read_b64_tr_b16 v[64:65], v3 offset:22528
    ds_read_b64_tr_b16 v[66:67], v3 offset:23040
    v_mfma_f32_32x32x16_bf16 v[192:207], v[36:39], v[56:59], v[192:207]
    ds_read_b64_tr_b16 v[68:69], v4 offset:22528
    ds_read_b64_tr_b16 v[70:71], v4 offset:23040
    v_mfma_f32_32x32x16_bf16 v[128:143], v[40:43], v[52:55], v[128:143]
    ds_read_b64_tr_b16 v[72:73], v5 offset:22528
    ds_read_b64_tr_b16 v[74:75], v5 offset:23040
    v_mfma_f32_32x32x16_bf16 v[208:223], v[40:43], v[56:59], v[208:223]
    ds_read_b64_tr_b16 v[76:77], v6 offset:22528
    ds_read_b64_tr_b16 v[78:79], v6 offset:23040
    v_mfma_f32_32x32x16_bf16 v[144:159], v[44:47], v[52:55], v[144:159]
    v_mfma_f32_32x32x16_bf16 v[224:239], v[44:47], v[56:59], v[224:239]
    v_mfma_f32_32x32x16_bf16 v[160:175], v[48:51], v[52:55], v[160:175]
    v_mfma_f32_32x32x16_bf16 v[240:255], v[48:51], v[56:59], v[240:255]
    s_waitcnt lgkmcnt(0)
    v_mfma_f32_32x32x16_bf16 v[96:111], v[60:63], v[80:83], v[96:111]
    s_barrier
    ds_read_b128 v[52:55], v12 offset:18432
    ds_read_b64_tr_b16 v[32:33], v2 offset:40960
    v_mfma_f32_32x32x16_bf16 v[176:191], v[60:63], v[84:87], v[176:191]
    ds_read_b64_tr_b16 v[34:35], v2 offset:41472
    ds_read_b128 v[56:59], v12 offset:22528
    v_mfma_f32_32x32x16_bf16 v[112:127], v[64:67], v[80:83], v[112:127]
    ds_read_b64_tr_b16 v[36:37], v3 offset:40960
    ds_read_b64_tr_b16 v[38:39], v3 offset:41472
    v_mfma_f32_32x32x16_bf16 v[192:207], v[64:67], v[84:87], v[192:207]
    ds_read_b64_tr_b16 v[40:41], v4 offset:40960
    ds_read_b64_tr_b16 v[42:43], v4 offset:41472
    v_mfma_f32_32x32x16_bf16 v[128:143], v[68:71], v[80:83], v[128:143]
    ds_read_b64_tr_b16 v[44:45], v5 offset:40960
    ds_read_b64_tr_b16 v[46:47], v5 offset:41472
    v_mfma_f32_32x32x16_bf16 v[208:223], v[68:71], v[84:87], v[208:223]
    ds_read_b64_tr_b16 v[48:49], v6 offset:40960
    ds_read_b64_tr_b16 v[50:51], v6 offset:41472
    v_mfma_f32_32x32x16_bf16 v[144:159], v[72:75], v[80:83], v[144:159]
    v_mfma_f32_32x32x16_bf16 v[224:239], v[72:75], v[84:87], v[224:239]
    v_mfma_f32_32x32x16_bf16 v[160:175], v[76:79], v[80:83], v[160:175]
    v_mfma_f32_32x32x16_bf16 v[240:255], v[76:79], v[84:87], v[240:255]
    s_waitcnt lgkmcnt(0)
    v_mfma_f32_32x32x16_bf16 v[96:111], v[32:35], v[52:55], v[96:111]
    ds_read_b128 v[80:83], v13 offset:18432
    ds_read_b64_tr_b16 v[60:61], v2 offset:43008
    v_mfma_f32_32x32x16_bf16 v[176:191], v[32:35], v[56:59], v[176:191]
    ds_read_b64_tr_b16 v[62:63], v2 offset:43520
    ds_read_b128 v[84:87], v13 offset:22528
    v_mfma_f32_32x32x16_bf16 v[112:127], v[36:39], v[52:55], v[112:127]
    ds_read_b64_tr_b16 v[64:65], v3 offset:43008
    ds_read_b64_tr_b16 v[66:67], v3 offset:43520
    v_mfma_f32_32x32x16_bf16 v[192:207], v[36:39], v[56:59], v[192:207]
    ds_read_b64_tr_b16 v[68:69], v4 offset:43008
    ds_read_b64_tr_b16 v[70:71], v4 offset:43520
    v_mfma_f32_32x32x16_bf16 v[128:143], v[40:43], v[52:55], v[128:143]
    ds_read_b64_tr_b16 v[72:73], v5 offset:43008
    ds_read_b64_tr_b16 v[74:75], v5 offset:43520
    v_mfma_f32_32x32x16_bf16 v[208:223], v[40:43], v[56:59], v[208:223]
    ds_read_b64_tr_b16 v[76:77], v6 offset:43008
    ds_read_b64_tr_b16 v[78:79], v6 offset:43520
    v_mfma_f32_32x32x16_bf16 v[144:159], v[44:47], v[52:55], v[144:159]
    v_mfma_f32_32x32x16_bf16 v[224:239], v[44:47], v[56:59], v[224:239]
    v_mfma_f32_32x32x16_bf16 v[160:175], v[48:51], v[52:55], v[160:175]
    v_mfma_f32_32x32x16_bf16 v[240:255], v[48:51], v[56:59], v[240:255]
    s_waitcnt lgkmcnt(0)
    v_mfma_f32_32x32x16_bf16 v[96:111], v[60:63], v[80:83], v[96:111]
    s_barrier
    ds_read_b128 v[52:55], v14 offset:18432
    ds_read_b64_tr_b16 v[32:33], v2 offset:61440
    v_mfma_f32_32x32x16_bf16 v[176:191], v[60:63], v[84:87], v[176:191]
    ds_read_b64_tr_b16 v[34:35], v2 offset:61952
    ds_read_b128 v[56:59], v14 offset:22528
    v_mfma_f32_32x32x16_bf16 v[112:127], v[64:67], v[80:83], v[112:127]
    ds_read_b64_tr_b16 v[36:37], v3 offset:61440
    ds_read_b64_tr_b16 v[38:39], v3 offset:61952
    v_mfma_f32_32x32x16_bf16 v[192:207], v[64:67], v[84:87], v[192:207]
    ds_read_b64_tr_b16 v[40:41], v4 offset:61440
    ds_read_b64_tr_b16 v[42:43], v4 offset:61952
    v_mfma_f32_32x32x16_bf16 v[128:143], v[68:71], v[80:83], v[128:143]
    ds_read_b64_tr_b16 v[44:45], v5 offset:61440
    ds_read_b64_tr_b16 v[46:47], v5 offset:61952
    v_mfma_f32_32x32x16_bf16 v[208:223], v[68:71], v[84:87], v[208:223]
    ds_read_b64_tr_b16 v[48:49], v6 offset:61440
    ds_read_b64_tr_b16 v[50:51], v6 offset:61952
    v_mfma_f32_32x32x16_bf16 v[144:159], v[72:75], v[80:83], v[144:159]
    v_mfma_f32_32x32x16_bf16 v[224:239], v[72:75], v[84:87], v[224:239]
    v_mfma_f32_32x32x16_bf16 v[160:175], v[76:79], v[80:83], v[160:175]
    v_mfma_f32_32x32x16_bf16 v[240:255], v[76:79], v[84:87], v[240:255]
    s_waitcnt lgkmcnt(0)
    v_mfma_f32_32x32x16_bf16 v[96:111], v[32:35], v[52:55], v[96:111]
    ds_read_b128 v[80:83], v15 offset:18432
    ds_read_b64_tr_b16 v[60:61], v2 offset:63488
    v_mfma_f32_32x32x16_bf16 v[176:191], v[32:35], v[56:59], v[176:191]
    ds_read_b64_tr_b16 v[62:63], v2 offset:64000
    ds_read_b128 v[84:87], v15 offset:22528
    v_mfma_f32_32x32x16_bf16 v[112:127], v[36:39], v[52:55], v[112:127]
    ds_read_b64_tr_b16 v[64:65], v3 offset:63488
    ds_read_b64_tr_b16 v[66:67], v3 offset:64000
    v_mfma_f32_32x32x16_bf16 v[192:207], v[36:39], v[56:59], v[192:207]
    ds_read_b64_tr_b16 v[68:69], v4 offset:63488
    ds_read_b64_tr_b16 v[70:71], v4 offset:64000
    v_mfma_f32_32x32x16_bf16 v[128:143], v[40:43], v[52:55], v[128:143]
    ds_read_b64_tr_b16 v[72:73], v5 offset:63488
    ds_read_b64_tr_b16 v[74:75], v5 offset:64000
    v_mfma_f32_32x32x16_bf16 v[208:223], v[40:43], v[56:59], v[208:223]
    ds_read_b64_tr_b16 v[76:77], v6 offset:63488
    ds_read_b64_tr_b16 v[78:79], v6 offset:64000
    v_mfma_f32_32x32x16_bf16 v[144:159], v[44:47], v[52:55], v[144:159]
    v_mfma_f32_32x32x16_bf16 v[224:239], v[44:47], v[56:59], v[224:239]
    v_mfma_f32_32x32x16_bf16 v[160:175], v[48:51], v[52:55], v[160:175]
    v_mfma_f32_32x32x16_bf16 v[240:255], v[48:51], v[56:59], v[240:255]
    s_waitcnt lgkmcnt(0)
    v_mfma_f32_32x32x16_bf16 v[96:111], v[60:63], v[80:83], v[96:111]
    s_barrier
    ds_read_b128 v[52:55], v12 offset:36864
    v_add_u32 v2, 81920, v2
    ds_read_b64_tr_b16 v[32:33], v2 offset:0
    v_mfma_f32_32x32x16_bf16 v[176:191], v[60:63], v[84:87], v[176:191]
    ds_read_b64_tr_b16 v[34:35], v2 offset:512
    ds_read_b128 v[56:59], v12 offset:40960
    v_mfma_f32_32x32x16_bf16 v[112:127], v[64:67], v[80:83], v[112:127]
    v_add_u32 v3, 81920, v3
    ds_read_b64_tr_b16 v[36:37], v3 offset:0
    ds_read_b64_tr_b16 v[38:39], v3 offset:512
    v_mfma_f32_32x32x16_bf16 v[192:207], v[64:67], v[84:87], v[192:207]
    v_add_u32 v4, 81920, v4
    ds_read_b64_tr_b16 v[40:41], v4 offset:0
    ds_read_b64_tr_b16 v[42:43], v4 offset:512
    v_mfma_f32_32x32x16_bf16 v[128:143], v[68:71], v[80:83], v[128:143]
    v_add_u32 v5, 81920, v5
    ds_read_b64_tr_b16 v[44:45], v5 offset:0
    ds_read_b64_tr_b16 v[46:47], v5 offset:512
    v_mfma_f32_32x32x16_bf16 v[208:223], v[68:71], v[84:87], v[208:223]
    v_add_u32 v6, 81920, v6
    ds_read_b64_tr_b16 v[48:49], v6 offset:0
    ds_read_b64_tr_b16 v[50:51], v6 offset:512
    v_mfma_f32_32x32x16_bf16 v[144:159], v[72:75], v[80:83], v[144:159]
    v_mfma_f32_32x32x16_bf16 v[224:239], v[72:75], v[84:87], v[224:239]
    v_mfma_f32_32x32x16_bf16 v[160:175], v[76:79], v[80:83], v[160:175]
    v_mfma_f32_32x32x16_bf16 v[240:255], v[76:79], v[84:87], v[240:255]
    s_waitcnt lgkmcnt(0)
    v_mfma_f32_32x32x16_bf16 v[96:111], v[32:35], v[52:55], v[96:111]
    ds_read_b128 v[80:83], v13 offset:36864
    ds_read_b64_tr_b16 v[60:61], v2 offset:2048
    v_mfma_f32_32x32x16_bf16 v[176:191], v[32:35], v[56:59], v[176:191]
    ds_read_b64_tr_b16 v[62:63], v2 offset:2560
    ds_read_b128 v[84:87], v13 offset:40960
    v_mfma_f32_32x32x16_bf16 v[112:127], v[36:39], v[52:55], v[112:127]
    ds_read_b64_tr_b16 v[64:65], v3 offset:2048
    ds_read_b64_tr_b16 v[66:67], v3 offset:2560
    v_mfma_f32_32x32x16_bf16 v[192:207], v[36:39], v[56:59], v[192:207]
    ds_read_b64_tr_b16 v[68:69], v4 offset:2048
    ds_read_b64_tr_b16 v[70:71], v4 offset:2560
    v_mfma_f32_32x32x16_bf16 v[128:143], v[40:43], v[52:55], v[128:143]
    ds_read_b64_tr_b16 v[72:73], v5 offset:2048
    ds_read_b64_tr_b16 v[74:75], v5 offset:2560
    v_mfma_f32_32x32x16_bf16 v[208:223], v[40:43], v[56:59], v[208:223]
    ds_read_b64_tr_b16 v[76:77], v6 offset:2048
    ds_read_b64_tr_b16 v[78:79], v6 offset:2560
    v_mfma_f32_32x32x16_bf16 v[144:159], v[44:47], v[52:55], v[144:159]
    v_mfma_f32_32x32x16_bf16 v[224:239], v[44:47], v[56:59], v[224:239]
    v_mfma_f32_32x32x16_bf16 v[160:175], v[48:51], v[52:55], v[160:175]
    v_mfma_f32_32x32x16_bf16 v[240:255], v[48:51], v[56:59], v[240:255]
    s_waitcnt lgkmcnt(0)
    v_mfma_f32_32x32x16_bf16 v[96:111], v[60:63], v[80:83], v[96:111]
    s_barrier
    ds_read_b128 v[52:55], v14 offset:36864
    v_subrev_u32 v2, 81920, v2
    ds_read_b64_tr_b16 v[32:33], v2 offset:0
    v_mfma_f32_32x32x16_bf16 v[176:191], v[60:63], v[84:87], v[176:191]
    ds_read_b64_tr_b16 v[34:35], v2 offset:512
    ds_read_b128 v[56:59], v14 offset:40960
    v_mfma_f32_32x32x16_bf16 v[112:127], v[64:67], v[80:83], v[112:127]
    v_subrev_u32 v3, 81920, v3
    ds_read_b64_tr_b16 v[36:37], v3 offset:0
    ds_read_b64_tr_b16 v[38:39], v3 offset:512
    v_mfma_f32_32x32x16_bf16 v[192:207], v[64:67], v[84:87], v[192:207]
    v_subrev_u32 v4, 81920, v4
    ds_read_b64_tr_b16 v[40:41], v4 offset:0
    ds_read_b64_tr_b16 v[42:43], v4 offset:512
    v_mfma_f32_32x32x16_bf16 v[128:143], v[68:71], v[80:83], v[128:143]
    v_subrev_u32 v5, 81920, v5
    ds_read_b64_tr_b16 v[44:45], v5 offset:0
    ds_read_b64_tr_b16 v[46:47], v5 offset:512
    v_mfma_f32_32x32x16_bf16 v[208:223], v[68:71], v[84:87], v[208:223]
    v_subrev_u32 v6, 81920, v6
    ds_read_b64_tr_b16 v[48:49], v6 offset:0
    ds_read_b64_tr_b16 v[50:51], v6 offset:512
    v_mfma_f32_32x32x16_bf16 v[144:159], v[72:75], v[80:83], v[144:159]
    v_mfma_f32_32x32x16_bf16 v[224:239], v[72:75], v[84:87], v[224:239]
    v_mfma_f32_32x32x16_bf16 v[160:175], v[76:79], v[80:83], v[160:175]
    v_mfma_f32_32x32x16_bf16 v[240:255], v[76:79], v[84:87], v[240:255]
    s_waitcnt lgkmcnt(0)
    v_mfma_f32_32x32x16_bf16 v[96:111], v[32:35], v[52:55], v[96:111]
    ds_read_b128 v[80:83], v15 offset:36864
    ds_read_b64_tr_b16 v[60:61], v2 offset:2048
    v_mfma_f32_32x32x16_bf16 v[176:191], v[32:35], v[56:59], v[176:191]
    ds_read_b64_tr_b16 v[62:63], v2 offset:2560
    ds_read_b128 v[84:87], v15 offset:40960
    v_mfma_f32_32x32x16_bf16 v[112:127], v[36:39], v[52:55], v[112:127]
    ds_read_b64_tr_b16 v[64:65], v3 offset:2048
    ds_read_b64_tr_b16 v[66:67], v3 offset:2560
    v_mfma_f32_32x32x16_bf16 v[192:207], v[36:39], v[56:59], v[192:207]
    ds_read_b64_tr_b16 v[68:69], v4 offset:2048
    ds_read_b64_tr_b16 v[70:71], v4 offset:2560
    v_mfma_f32_32x32x16_bf16 v[128:143], v[40:43], v[52:55], v[128:143]
    ds_read_b64_tr_b16 v[72:73], v5 offset:2048
    ds_read_b64_tr_b16 v[74:75], v5 offset:2560
    v_mfma_f32_32x32x16_bf16 v[208:223], v[40:43], v[56:59], v[208:223]
    ds_read_b64_tr_b16 v[76:77], v6 offset:2048
    ds_read_b64_tr_b16 v[78:79], v6 offset:2560
    v_mfma_f32_32x32x16_bf16 v[144:159], v[44:47], v[52:55], v[144:159]
    v_mfma_f32_32x32x16_bf16 v[224:239], v[44:47], v[56:59], v[224:239]
    v_mfma_f32_32x32x16_bf16 v[160:175], v[48:51], v[52:55], v[160:175]
    v_mfma_f32_32x32x16_bf16 v[240:255], v[48:51], v[56:59], v[240:255]
    s_waitcnt lgkmcnt(0)
    v_mfma_f32_32x32x16_bf16 v[96:111], v[60:63], v[80:83], v[96:111]
    s_barrier
    ds_read_b128 v[52:55], v12 offset:0
    ds_read_b64_tr_b16 v[32:33], v2 offset:20480
    v_mfma_f32_32x32x16_bf16 v[176:191], v[60:63], v[84:87], v[176:191]
    ds_read_b64_tr_b16 v[34:35], v2 offset:20992
    ds_read_b128 v[56:59], v12 offset:4096
    v_mfma_f32_32x32x16_bf16 v[112:127], v[64:67], v[80:83], v[112:127]
    ds_read_b64_tr_b16 v[36:37], v3 offset:20480
    ds_read_b64_tr_b16 v[38:39], v3 offset:20992
    v_mfma_f32_32x32x16_bf16 v[192:207], v[64:67], v[84:87], v[192:207]
    ds_read_b64_tr_b16 v[40:41], v4 offset:20480
    ds_read_b64_tr_b16 v[42:43], v4 offset:20992
    v_mfma_f32_32x32x16_bf16 v[128:143], v[68:71], v[80:83], v[128:143]
    ds_read_b64_tr_b16 v[44:45], v5 offset:20480
    ds_read_b64_tr_b16 v[46:47], v5 offset:20992
    v_mfma_f32_32x32x16_bf16 v[208:223], v[68:71], v[84:87], v[208:223]
    ds_read_b64_tr_b16 v[48:49], v6 offset:20480
    ds_read_b64_tr_b16 v[50:51], v6 offset:20992
    v_mfma_f32_32x32x16_bf16 v[144:159], v[72:75], v[80:83], v[144:159]
    v_mfma_f32_32x32x16_bf16 v[224:239], v[72:75], v[84:87], v[224:239]
    v_mfma_f32_32x32x16_bf16 v[160:175], v[76:79], v[80:83], v[160:175]
    v_mfma_f32_32x32x16_bf16 v[240:255], v[76:79], v[84:87], v[240:255]
    s_waitcnt lgkmcnt(0)
    v_mfma_f32_32x32x16_bf16 v[96:111], v[32:35], v[52:55], v[96:111]
    ds_read_b128 v[80:83], v13 offset:0
    ds_read_b64_tr_b16 v[60:61], v2 offset:22528
    v_mfma_f32_32x32x16_bf16 v[176:191], v[32:35], v[56:59], v[176:191]
    ds_read_b64_tr_b16 v[62:63], v2 offset:23040
    ds_read_b128 v[84:87], v13 offset:4096
    v_mfma_f32_32x32x16_bf16 v[112:127], v[36:39], v[52:55], v[112:127]
    ds_read_b64_tr_b16 v[64:65], v3 offset:22528
    ds_read_b64_tr_b16 v[66:67], v3 offset:23040
    v_mfma_f32_32x32x16_bf16 v[192:207], v[36:39], v[56:59], v[192:207]
    ds_read_b64_tr_b16 v[68:69], v4 offset:22528
    ds_read_b64_tr_b16 v[70:71], v4 offset:23040
    v_mfma_f32_32x32x16_bf16 v[128:143], v[40:43], v[52:55], v[128:143]
    ds_read_b64_tr_b16 v[72:73], v5 offset:22528
    ds_read_b64_tr_b16 v[74:75], v5 offset:23040
    v_mfma_f32_32x32x16_bf16 v[208:223], v[40:43], v[56:59], v[208:223]
    ds_read_b64_tr_b16 v[76:77], v6 offset:22528
    ds_read_b64_tr_b16 v[78:79], v6 offset:23040
    v_mfma_f32_32x32x16_bf16 v[144:159], v[44:47], v[52:55], v[144:159]
    v_mfma_f32_32x32x16_bf16 v[224:239], v[44:47], v[56:59], v[224:239]
    v_mfma_f32_32x32x16_bf16 v[160:175], v[48:51], v[52:55], v[160:175]
    v_mfma_f32_32x32x16_bf16 v[240:255], v[48:51], v[56:59], v[240:255]
    s_waitcnt lgkmcnt(0)
    v_mfma_f32_32x32x16_bf16 v[96:111], v[60:63], v[80:83], v[96:111]
    s_barrier
    ds_read_b128 v[52:55], v14 offset:0
    ds_read_b64_tr_b16 v[32:33], v2 offset:40960
    v_mfma_f32_32x32x16_bf16 v[176:191], v[60:63], v[84:87], v[176:191]
    ds_read_b64_tr_b16 v[34:35], v2 offset:41472
    ds_read_b128 v[56:59], v14 offset:4096
    v_mfma_f32_32x32x16_bf16 v[112:127], v[64:67], v[80:83], v[112:127]
    ds_read_b64_tr_b16 v[36:37], v3 offset:40960
    ds_read_b64_tr_b16 v[38:39], v3 offset:41472
    v_mfma_f32_32x32x16_bf16 v[192:207], v[64:67], v[84:87], v[192:207]
    ds_read_b64_tr_b16 v[40:41], v4 offset:40960
    ds_read_b64_tr_b16 v[42:43], v4 offset:41472
    v_mfma_f32_32x32x16_bf16 v[128:143], v[68:71], v[80:83], v[128:143]
    ds_read_b64_tr_b16 v[44:45], v5 offset:40960
    ds_read_b64_tr_b16 v[46:47], v5 offset:41472
    v_mfma_f32_32x32x16_bf16 v[208:223], v[68:71], v[84:87], v[208:223]
    ds_read_b64_tr_b16 v[48:49], v6 offset:40960
    ds_read_b64_tr_b16 v[50:51], v6 offset:41472
    v_mfma_f32_32x32x16_bf16 v[144:159], v[72:75], v[80:83], v[144:159]
    v_mfma_f32_32x32x16_bf16 v[224:239], v[72:75], v[84:87], v[224:239]
    v_mfma_f32_32x32x16_bf16 v[160:175], v[76:79], v[80:83], v[160:175]
    v_mfma_f32_32x32x16_bf16 v[240:255], v[76:79], v[84:87], v[240:255]
    s_waitcnt lgkmcnt(0)
    v_mfma_f32_32x32x16_bf16 v[96:111], v[32:35], v[52:55], v[96:111]
    ds_read_b128 v[80:83], v15 offset:0
    ds_read_b64_tr_b16 v[60:61], v2 offset:43008
    v_mfma_f32_32x32x16_bf16 v[176:191], v[32:35], v[56:59], v[176:191]
    ds_read_b64_tr_b16 v[62:63], v2 offset:43520
    ds_read_b128 v[84:87], v15 offset:4096
    v_mfma_f32_32x32x16_bf16 v[112:127], v[36:39], v[52:55], v[112:127]
    ds_read_b64_tr_b16 v[64:65], v3 offset:43008
    ds_read_b64_tr_b16 v[66:67], v3 offset:43520
    v_mfma_f32_32x32x16_bf16 v[192:207], v[36:39], v[56:59], v[192:207]
    ds_read_b64_tr_b16 v[68:69], v4 offset:43008
    ds_read_b64_tr_b16 v[70:71], v4 offset:43520
    v_mfma_f32_32x32x16_bf16 v[128:143], v[40:43], v[52:55], v[128:143]
    ds_read_b64_tr_b16 v[72:73], v5 offset:43008
    ds_read_b64_tr_b16 v[74:75], v5 offset:43520
    v_mfma_f32_32x32x16_bf16 v[208:223], v[40:43], v[56:59], v[208:223]
    ds_read_b64_tr_b16 v[76:77], v6 offset:43008
    ds_read_b64_tr_b16 v[78:79], v6 offset:43520
    v_mfma_f32_32x32x16_bf16 v[144:159], v[44:47], v[52:55], v[144:159]
    v_mfma_f32_32x32x16_bf16 v[224:239], v[44:47], v[56:59], v[224:239]
    v_mfma_f32_32x32x16_bf16 v[160:175], v[48:51], v[52:55], v[160:175]
    v_mfma_f32_32x32x16_bf16 v[240:255], v[48:51], v[56:59], v[240:255]
    s_waitcnt lgkmcnt(0)
    s_waitcnt vmcnt(0)
    v_mfma_f32_32x32x16_bf16 v[96:111], v[60:63], v[80:83], v[96:111]
    s_barrier
    ds_read_b128 v[52:55], v12 offset:18432
    ds_read_b64_tr_b16 v[32:33], v2 offset:61440
    v_mfma_f32_32x32x16_bf16 v[176:191], v[60:63], v[84:87], v[176:191]
    ds_read_b64_tr_b16 v[34:35], v2 offset:61952
    ds_read_b128 v[56:59], v12 offset:22528
    v_mfma_f32_32x32x16_bf16 v[112:127], v[64:67], v[80:83], v[112:127]
    ds_read_b64_tr_b16 v[36:37], v3 offset:61440
    ds_read_b64_tr_b16 v[38:39], v3 offset:61952
    v_mfma_f32_32x32x16_bf16 v[192:207], v[64:67], v[84:87], v[192:207]
    ds_read_b64_tr_b16 v[40:41], v4 offset:61440
    ds_read_b64_tr_b16 v[42:43], v4 offset:61952
    v_mfma_f32_32x32x16_bf16 v[128:143], v[68:71], v[80:83], v[128:143]
    ds_read_b64_tr_b16 v[44:45], v5 offset:61440
    ds_read_b64_tr_b16 v[46:47], v5 offset:61952
    v_mfma_f32_32x32x16_bf16 v[208:223], v[68:71], v[84:87], v[208:223]
    ds_read_b64_tr_b16 v[48:49], v6 offset:61440
    ds_read_b64_tr_b16 v[50:51], v6 offset:61952
    v_mfma_f32_32x32x16_bf16 v[144:159], v[72:75], v[80:83], v[144:159]
    v_mfma_f32_32x32x16_bf16 v[224:239], v[72:75], v[84:87], v[224:239]
    v_mfma_f32_32x32x16_bf16 v[160:175], v[76:79], v[80:83], v[160:175]
    v_mfma_f32_32x32x16_bf16 v[240:255], v[76:79], v[84:87], v[240:255]
    s_waitcnt lgkmcnt(0)
    v_mfma_f32_32x32x16_bf16 v[96:111], v[32:35], v[52:55], v[96:111]
    ds_read_b128 v[80:83], v13 offset:18432
    ds_read_b64_tr_b16 v[60:61], v2 offset:63488
    v_mfma_f32_32x32x16_bf16 v[176:191], v[32:35], v[56:59], v[176:191]
    ds_read_b64_tr_b16 v[62:63], v2 offset:64000
    ds_read_b128 v[84:87], v13 offset:22528
    v_mfma_f32_32x32x16_bf16 v[112:127], v[36:39], v[52:55], v[112:127]
    ds_read_b64_tr_b16 v[64:65], v3 offset:63488
    ds_read_b64_tr_b16 v[66:67], v3 offset:64000
    v_mfma_f32_32x32x16_bf16 v[192:207], v[36:39], v[56:59], v[192:207]
    ds_read_b64_tr_b16 v[68:69], v4 offset:63488
    ds_read_b64_tr_b16 v[70:71], v4 offset:64000
    v_mfma_f32_32x32x16_bf16 v[128:143], v[40:43], v[52:55], v[128:143]
    ds_read_b64_tr_b16 v[72:73], v5 offset:63488
    ds_read_b64_tr_b16 v[74:75], v5 offset:64000
    v_mfma_f32_32x32x16_bf16 v[208:223], v[40:43], v[56:59], v[208:223]
    ds_read_b64_tr_b16 v[76:77], v6 offset:63488
    ds_read_b64_tr_b16 v[78:79], v6 offset:64000
    v_mfma_f32_32x32x16_bf16 v[144:159], v[44:47], v[52:55], v[144:159]
    v_mfma_f32_32x32x16_bf16 v[224:239], v[44:47], v[56:59], v[224:239]
    v_mfma_f32_32x32x16_bf16 v[160:175], v[48:51], v[52:55], v[160:175]
    v_mfma_f32_32x32x16_bf16 v[240:255], v[48:51], v[56:59], v[240:255]
    s_waitcnt lgkmcnt(0)
    v_mfma_f32_32x32x16_bf16 v[96:111], v[60:63], v[80:83], v[96:111]
    s_barrier
    ds_read_b128 v[52:55], v14 offset:18432
    v_add_u32 v2, 81920, v2
    ds_read_b64_tr_b16 v[32:33], v2 offset:0
    v_mfma_f32_32x32x16_bf16 v[176:191], v[60:63], v[84:87], v[176:191]
    ds_read_b64_tr_b16 v[34:35], v2 offset:512
    ds_read_b128 v[56:59], v14 offset:22528
    v_mfma_f32_32x32x16_bf16 v[112:127], v[64:67], v[80:83], v[112:127]
    v_add_u32 v3, 81920, v3
    ds_read_b64_tr_b16 v[36:37], v3 offset:0
    ds_read_b64_tr_b16 v[38:39], v3 offset:512
    v_mfma_f32_32x32x16_bf16 v[192:207], v[64:67], v[84:87], v[192:207]
    v_add_u32 v4, 81920, v4
    ds_read_b64_tr_b16 v[40:41], v4 offset:0
    ds_read_b64_tr_b16 v[42:43], v4 offset:512
    v_mfma_f32_32x32x16_bf16 v[128:143], v[68:71], v[80:83], v[128:143]
    v_add_u32 v5, 81920, v5
    ds_read_b64_tr_b16 v[44:45], v5 offset:0
    ds_read_b64_tr_b16 v[46:47], v5 offset:512
    v_mfma_f32_32x32x16_bf16 v[208:223], v[68:71], v[84:87], v[208:223]
    v_add_u32 v6, 81920, v6
    ds_read_b64_tr_b16 v[48:49], v6 offset:0
    ds_read_b64_tr_b16 v[50:51], v6 offset:512
    v_mfma_f32_32x32x16_bf16 v[144:159], v[72:75], v[80:83], v[144:159]
    v_mfma_f32_32x32x16_bf16 v[224:239], v[72:75], v[84:87], v[224:239]
    v_mfma_f32_32x32x16_bf16 v[160:175], v[76:79], v[80:83], v[160:175]
    v_mfma_f32_32x32x16_bf16 v[240:255], v[76:79], v[84:87], v[240:255]
    s_waitcnt lgkmcnt(0)
    v_mfma_f32_32x32x16_bf16 v[96:111], v[32:35], v[52:55], v[96:111]
    ds_read_b128 v[80:83], v15 offset:18432
    ds_read_b64_tr_b16 v[60:61], v2 offset:2048
    v_mfma_f32_32x32x16_bf16 v[176:191], v[32:35], v[56:59], v[176:191]
    ds_read_b64_tr_b16 v[62:63], v2 offset:2560
    ds_read_b128 v[84:87], v15 offset:22528
    v_mfma_f32_32x32x16_bf16 v[112:127], v[36:39], v[52:55], v[112:127]
    ds_read_b64_tr_b16 v[64:65], v3 offset:2048
    ds_read_b64_tr_b16 v[66:67], v3 offset:2560
    v_mfma_f32_32x32x16_bf16 v[192:207], v[36:39], v[56:59], v[192:207]
    ds_read_b64_tr_b16 v[68:69], v4 offset:2048
    ds_read_b64_tr_b16 v[70:71], v4 offset:2560
    v_mfma_f32_32x32x16_bf16 v[128:143], v[40:43], v[52:55], v[128:143]
    ds_read_b64_tr_b16 v[72:73], v5 offset:2048
    ds_read_b64_tr_b16 v[74:75], v5 offset:2560
    v_mfma_f32_32x32x16_bf16 v[208:223], v[40:43], v[56:59], v[208:223]
    ds_read_b64_tr_b16 v[76:77], v6 offset:2048
    ds_read_b64_tr_b16 v[78:79], v6 offset:2560
    v_mfma_f32_32x32x16_bf16 v[144:159], v[44:47], v[52:55], v[144:159]
    v_mfma_f32_32x32x16_bf16 v[224:239], v[44:47], v[56:59], v[224:239]
    v_mfma_f32_32x32x16_bf16 v[160:175], v[48:51], v[52:55], v[160:175]
    v_mfma_f32_32x32x16_bf16 v[240:255], v[48:51], v[56:59], v[240:255]
    s_waitcnt lgkmcnt(0)
    v_mfma_f32_32x32x16_bf16 v[96:111], v[60:63], v[80:83], v[96:111]
    s_barrier
    ds_read_b128 v[52:55], v12 offset:36864
    v_subrev_u32 v2, 81920, v2
    ds_read_b64_tr_b16 v[32:33], v2 offset:0
    v_mfma_f32_32x32x16_bf16 v[176:191], v[60:63], v[84:87], v[176:191]
    ds_read_b64_tr_b16 v[34:35], v2 offset:512
    ds_read_b128 v[56:59], v12 offset:40960
    v_mfma_f32_32x32x16_bf16 v[112:127], v[64:67], v[80:83], v[112:127]
    v_subrev_u32 v3, 81920, v3
    ds_read_b64_tr_b16 v[36:37], v3 offset:0
    ds_read_b64_tr_b16 v[38:39], v3 offset:512
    v_mfma_f32_32x32x16_bf16 v[192:207], v[64:67], v[84:87], v[192:207]
    v_subrev_u32 v4, 81920, v4
    ds_read_b64_tr_b16 v[40:41], v4 offset:0
    ds_read_b64_tr_b16 v[42:43], v4 offset:512
    v_mfma_f32_32x32x16_bf16 v[128:143], v[68:71], v[80:83], v[128:143]
    v_subrev_u32 v5, 81920, v5
    ds_read_b64_tr_b16 v[44:45], v5 offset:0
    ds_read_b64_tr_b16 v[46:47], v5 offset:512
    v_mfma_f32_32x32x16_bf16 v[208:223], v[68:71], v[84:87], v[208:223]
    v_subrev_u32 v6, 81920, v6
    ds_read_b64_tr_b16 v[48:49], v6 offset:0
    ds_read_b64_tr_b16 v[50:51], v6 offset:512
    v_mfma_f32_32x32x16_bf16 v[144:159], v[72:75], v[80:83], v[144:159]
    v_mfma_f32_32x32x16_bf16 v[224:239], v[72:75], v[84:87], v[224:239]
    v_mfma_f32_32x32x16_bf16 v[160:175], v[76:79], v[80:83], v[160:175]
    v_mfma_f32_32x32x16_bf16 v[240:255], v[76:79], v[84:87], v[240:255]
    s_waitcnt lgkmcnt(0)
    v_mfma_f32_32x32x16_bf16 v[96:111], v[32:35], v[52:55], v[96:111]
    ds_read_b128 v[80:83], v13 offset:36864
    ds_read_b64_tr_b16 v[60:61], v2 offset:2048
    v_mfma_f32_32x32x16_bf16 v[176:191], v[32:35], v[56:59], v[176:191]
    ds_read_b64_tr_b16 v[62:63], v2 offset:2560
    ds_read_b128 v[84:87], v13 offset:40960
    v_mfma_f32_32x32x16_bf16 v[112:127], v[36:39], v[52:55], v[112:127]
    ds_read_b64_tr_b16 v[64:65], v3 offset:2048
    ds_read_b64_tr_b16 v[66:67], v3 offset:2560
    v_mfma_f32_32x32x16_bf16 v[192:207], v[36:39], v[56:59], v[192:207]
    ds_read_b64_tr_b16 v[68:69], v4 offset:2048
    ds_read_b64_tr_b16 v[70:71], v4 offset:2560
    v_mfma_f32_32x32x16_bf16 v[128:143], v[40:43], v[52:55], v[128:143]
    ds_read_b64_tr_b16 v[72:73], v5 offset:2048
    ds_read_b64_tr_b16 v[74:75], v5 offset:2560
    v_mfma_f32_32x32x16_bf16 v[208:223], v[40:43], v[56:59], v[208:223]
    ds_read_b64_tr_b16 v[76:77], v6 offset:2048
    ds_read_b64_tr_b16 v[78:79], v6 offset:2560
    v_mfma_f32_32x32x16_bf16 v[144:159], v[44:47], v[52:55], v[144:159]
    v_mfma_f32_32x32x16_bf16 v[224:239], v[44:47], v[56:59], v[224:239]
    v_mfma_f32_32x32x16_bf16 v[160:175], v[48:51], v[52:55], v[160:175]
    v_mfma_f32_32x32x16_bf16 v[240:255], v[48:51], v[56:59], v[240:255]
    s_waitcnt lgkmcnt(0)
    v_mfma_f32_32x32x16_bf16 v[96:111], v[60:63], v[80:83], v[96:111]
    s_barrier
    ds_read_b128 v[52:55], v14 offset:36864
    ds_read_b64_tr_b16 v[32:33], v2 offset:20480
    v_mfma_f32_32x32x16_bf16 v[176:191], v[60:63], v[84:87], v[176:191]
    ds_read_b64_tr_b16 v[34:35], v2 offset:20992
    ds_read_b128 v[56:59], v14 offset:40960
    v_mfma_f32_32x32x16_bf16 v[112:127], v[64:67], v[80:83], v[112:127]
    ds_read_b64_tr_b16 v[36:37], v3 offset:20480
    ds_read_b64_tr_b16 v[38:39], v3 offset:20992
    v_mfma_f32_32x32x16_bf16 v[192:207], v[64:67], v[84:87], v[192:207]
    ds_read_b64_tr_b16 v[40:41], v4 offset:20480
    ds_read_b64_tr_b16 v[42:43], v4 offset:20992
    v_mfma_f32_32x32x16_bf16 v[128:143], v[68:71], v[80:83], v[128:143]
    ds_read_b64_tr_b16 v[44:45], v5 offset:20480
    ds_read_b64_tr_b16 v[46:47], v5 offset:20992
    v_mfma_f32_32x32x16_bf16 v[208:223], v[68:71], v[84:87], v[208:223]
    ds_read_b64_tr_b16 v[48:49], v6 offset:20480
    ds_read_b64_tr_b16 v[50:51], v6 offset:20992
    v_mfma_f32_32x32x16_bf16 v[144:159], v[72:75], v[80:83], v[144:159]
    v_mfma_f32_32x32x16_bf16 v[224:239], v[72:75], v[84:87], v[224:239]
    v_mfma_f32_32x32x16_bf16 v[160:175], v[76:79], v[80:83], v[160:175]
    v_mfma_f32_32x32x16_bf16 v[240:255], v[76:79], v[84:87], v[240:255]
    s_waitcnt lgkmcnt(0)
    v_mfma_f32_32x32x16_bf16 v[96:111], v[32:35], v[52:55], v[96:111]
    ds_read_b128 v[80:83], v15 offset:36864
    ds_read_b64_tr_b16 v[60:61], v2 offset:22528
    v_mfma_f32_32x32x16_bf16 v[176:191], v[32:35], v[56:59], v[176:191]
    ds_read_b64_tr_b16 v[62:63], v2 offset:23040
    ds_read_b128 v[84:87], v15 offset:40960
    v_mfma_f32_32x32x16_bf16 v[112:127], v[36:39], v[52:55], v[112:127]
    ds_read_b64_tr_b16 v[64:65], v3 offset:22528
    ds_read_b64_tr_b16 v[66:67], v3 offset:23040
    v_mfma_f32_32x32x16_bf16 v[192:207], v[36:39], v[56:59], v[192:207]
    ds_read_b64_tr_b16 v[68:69], v4 offset:22528
    ds_read_b64_tr_b16 v[70:71], v4 offset:23040
    v_mfma_f32_32x32x16_bf16 v[128:143], v[40:43], v[52:55], v[128:143]
    ds_read_b64_tr_b16 v[72:73], v5 offset:22528
    ds_read_b64_tr_b16 v[74:75], v5 offset:23040
    v_mfma_f32_32x32x16_bf16 v[208:223], v[40:43], v[56:59], v[208:223]
    ds_read_b64_tr_b16 v[76:77], v6 offset:22528
    ds_read_b64_tr_b16 v[78:79], v6 offset:23040
    v_mfma_f32_32x32x16_bf16 v[144:159], v[44:47], v[52:55], v[144:159]
    v_mfma_f32_32x32x16_bf16 v[224:239], v[44:47], v[56:59], v[224:239]
    v_mfma_f32_32x32x16_bf16 v[160:175], v[48:51], v[52:55], v[160:175]
    v_mfma_f32_32x32x16_bf16 v[240:255], v[48:51], v[56:59], v[240:255]
    s_waitcnt lgkmcnt(0)
    v_mfma_f32_32x32x16_bf16 v[96:111], v[60:63], v[80:83], v[96:111]
    s_barrier
    ds_read_b128 v[52:55], v12 offset:0
    ds_read_b64_tr_b16 v[32:33], v2 offset:40960
    v_mfma_f32_32x32x16_bf16 v[176:191], v[60:63], v[84:87], v[176:191]
    ds_read_b64_tr_b16 v[34:35], v2 offset:41472
    ds_read_b128 v[56:59], v12 offset:4096
    v_mfma_f32_32x32x16_bf16 v[112:127], v[64:67], v[80:83], v[112:127]
    ds_read_b64_tr_b16 v[36:37], v3 offset:40960
    ds_read_b64_tr_b16 v[38:39], v3 offset:41472
    v_mfma_f32_32x32x16_bf16 v[192:207], v[64:67], v[84:87], v[192:207]
    ds_read_b64_tr_b16 v[40:41], v4 offset:40960
    ds_read_b64_tr_b16 v[42:43], v4 offset:41472
    v_mfma_f32_32x32x16_bf16 v[128:143], v[68:71], v[80:83], v[128:143]
    ds_read_b64_tr_b16 v[44:45], v5 offset:40960
    ds_read_b64_tr_b16 v[46:47], v5 offset:41472
    v_mfma_f32_32x32x16_bf16 v[208:223], v[68:71], v[84:87], v[208:223]
    ds_read_b64_tr_b16 v[48:49], v6 offset:40960
    ds_read_b64_tr_b16 v[50:51], v6 offset:41472
    v_mfma_f32_32x32x16_bf16 v[144:159], v[72:75], v[80:83], v[144:159]
    v_mfma_f32_32x32x16_bf16 v[224:239], v[72:75], v[84:87], v[224:239]
    v_mfma_f32_32x32x16_bf16 v[160:175], v[76:79], v[80:83], v[160:175]
    v_mfma_f32_32x32x16_bf16 v[240:255], v[76:79], v[84:87], v[240:255]
    s_waitcnt lgkmcnt(0)
    v_mfma_f32_32x32x16_bf16 v[96:111], v[32:35], v[52:55], v[96:111]
    ds_read_b128 v[80:83], v13 offset:0
    ds_read_b64_tr_b16 v[60:61], v2 offset:43008
    v_mfma_f32_32x32x16_bf16 v[176:191], v[32:35], v[56:59], v[176:191]
    ds_read_b64_tr_b16 v[62:63], v2 offset:43520
    ds_read_b128 v[84:87], v13 offset:4096
    v_mfma_f32_32x32x16_bf16 v[112:127], v[36:39], v[52:55], v[112:127]
    ds_read_b64_tr_b16 v[64:65], v3 offset:43008
    ds_read_b64_tr_b16 v[66:67], v3 offset:43520
    v_mfma_f32_32x32x16_bf16 v[192:207], v[36:39], v[56:59], v[192:207]
    ds_read_b64_tr_b16 v[68:69], v4 offset:43008
    ds_read_b64_tr_b16 v[70:71], v4 offset:43520
    v_mfma_f32_32x32x16_bf16 v[128:143], v[40:43], v[52:55], v[128:143]
    ds_read_b64_tr_b16 v[72:73], v5 offset:43008
    ds_read_b64_tr_b16 v[74:75], v5 offset:43520
    v_mfma_f32_32x32x16_bf16 v[208:223], v[40:43], v[56:59], v[208:223]
    ds_read_b64_tr_b16 v[76:77], v6 offset:43008
    ds_read_b64_tr_b16 v[78:79], v6 offset:43520
    v_mfma_f32_32x32x16_bf16 v[144:159], v[44:47], v[52:55], v[144:159]
    v_mfma_f32_32x32x16_bf16 v[224:239], v[44:47], v[56:59], v[224:239]
    v_mfma_f32_32x32x16_bf16 v[160:175], v[48:51], v[52:55], v[160:175]
    v_mfma_f32_32x32x16_bf16 v[240:255], v[48:51], v[56:59], v[240:255]
    s_waitcnt lgkmcnt(0)
    v_mfma_f32_32x32x16_bf16 v[96:111], v[60:63], v[80:83], v[96:111]
    s_barrier
    ds_read_b128 v[52:55], v14 offset:0
    ds_read_b64_tr_b16 v[32:33], v2 offset:61440
    v_mfma_f32_32x32x16_bf16 v[176:191], v[60:63], v[84:87], v[176:191]
    ds_read_b64_tr_b16 v[34:35], v2 offset:61952
    ds_read_b128 v[56:59], v14 offset:4096
    v_mfma_f32_32x32x16_bf16 v[112:127], v[64:67], v[80:83], v[112:127]
    ds_read_b64_tr_b16 v[36:37], v3 offset:61440
    ds_read_b64_tr_b16 v[38:39], v3 offset:61952
    v_mfma_f32_32x32x16_bf16 v[192:207], v[64:67], v[84:87], v[192:207]
    ds_read_b64_tr_b16 v[40:41], v4 offset:61440
    ds_read_b64_tr_b16 v[42:43], v4 offset:61952
    v_mfma_f32_32x32x16_bf16 v[128:143], v[68:71], v[80:83], v[128:143]
    ds_read_b64_tr_b16 v[44:45], v5 offset:61440
    ds_read_b64_tr_b16 v[46:47], v5 offset:61952
    v_mfma_f32_32x32x16_bf16 v[208:223], v[68:71], v[84:87], v[208:223]
    ds_read_b64_tr_b16 v[48:49], v6 offset:61440
    ds_read_b64_tr_b16 v[50:51], v6 offset:61952
    v_mfma_f32_32x32x16_bf16 v[144:159], v[72:75], v[80:83], v[144:159]
    v_mfma_f32_32x32x16_bf16 v[224:239], v[72:75], v[84:87], v[224:239]
    v_mfma_f32_32x32x16_bf16 v[160:175], v[76:79], v[80:83], v[160:175]
    v_mfma_f32_32x32x16_bf16 v[240:255], v[76:79], v[84:87], v[240:255]
    s_waitcnt lgkmcnt(0)
    v_mfma_f32_32x32x16_bf16 v[96:111], v[32:35], v[52:55], v[96:111]
    ds_read_b128 v[80:83], v15 offset:0
    ds_read_b64_tr_b16 v[60:61], v2 offset:63488
    v_mfma_f32_32x32x16_bf16 v[176:191], v[32:35], v[56:59], v[176:191]
    ds_read_b64_tr_b16 v[62:63], v2 offset:64000
    ds_read_b128 v[84:87], v15 offset:4096
    v_mfma_f32_32x32x16_bf16 v[112:127], v[36:39], v[52:55], v[112:127]
    ds_read_b64_tr_b16 v[64:65], v3 offset:63488
    ds_read_b64_tr_b16 v[66:67], v3 offset:64000
    v_mfma_f32_32x32x16_bf16 v[192:207], v[36:39], v[56:59], v[192:207]
    ds_read_b64_tr_b16 v[68:69], v4 offset:63488
    ds_read_b64_tr_b16 v[70:71], v4 offset:64000
    v_mfma_f32_32x32x16_bf16 v[128:143], v[40:43], v[52:55], v[128:143]
    ds_read_b64_tr_b16 v[72:73], v5 offset:63488
    ds_read_b64_tr_b16 v[74:75], v5 offset:64000
    v_mfma_f32_32x32x16_bf16 v[208:223], v[40:43], v[56:59], v[208:223]
    ds_read_b64_tr_b16 v[76:77], v6 offset:63488
    ds_read_b64_tr_b16 v[78:79], v6 offset:64000
    v_mfma_f32_32x32x16_bf16 v[144:159], v[44:47], v[52:55], v[144:159]
    v_mfma_f32_32x32x16_bf16 v[224:239], v[44:47], v[56:59], v[224:239]
    v_mfma_f32_32x32x16_bf16 v[160:175], v[48:51], v[52:55], v[160:175]
    v_mfma_f32_32x32x16_bf16 v[240:255], v[48:51], v[56:59], v[240:255]
    s_waitcnt lgkmcnt(0)
    v_mfma_f32_32x32x16_bf16 v[96:111], v[60:63], v[80:83], v[96:111]
    s_barrier
    ds_read_b128 v[52:55], v12 offset:18432
    v_add_u32 v2, 81920, v2
    ds_read_b64_tr_b16 v[32:33], v2 offset:0
    v_mfma_f32_32x32x16_bf16 v[176:191], v[60:63], v[84:87], v[176:191]
    ds_read_b64_tr_b16 v[34:35], v2 offset:512
    ds_read_b128 v[56:59], v12 offset:22528
    v_mfma_f32_32x32x16_bf16 v[112:127], v[64:67], v[80:83], v[112:127]
    v_add_u32 v3, 81920, v3
    ds_read_b64_tr_b16 v[36:37], v3 offset:0
    ds_read_b64_tr_b16 v[38:39], v3 offset:512
    v_mfma_f32_32x32x16_bf16 v[192:207], v[64:67], v[84:87], v[192:207]
    v_add_u32 v4, 81920, v4
    ds_read_b64_tr_b16 v[40:41], v4 offset:0
    ds_read_b64_tr_b16 v[42:43], v4 offset:512
    v_mfma_f32_32x32x16_bf16 v[128:143], v[68:71], v[80:83], v[128:143]
    v_add_u32 v5, 81920, v5
    ds_read_b64_tr_b16 v[44:45], v5 offset:0
    ds_read_b64_tr_b16 v[46:47], v5 offset:512
    v_mfma_f32_32x32x16_bf16 v[208:223], v[68:71], v[84:87], v[208:223]
    v_add_u32 v6, 81920, v6
    ds_read_b64_tr_b16 v[48:49], v6 offset:0
    ds_read_b64_tr_b16 v[50:51], v6 offset:512
    v_mfma_f32_32x32x16_bf16 v[144:159], v[72:75], v[80:83], v[144:159]
    v_mfma_f32_32x32x16_bf16 v[224:239], v[72:75], v[84:87], v[224:239]
    v_mfma_f32_32x32x16_bf16 v[160:175], v[76:79], v[80:83], v[160:175]
    v_mfma_f32_32x32x16_bf16 v[240:255], v[76:79], v[84:87], v[240:255]
    s_waitcnt lgkmcnt(0)
    v_mfma_f32_32x32x16_bf16 v[96:111], v[32:35], v[52:55], v[96:111]
    ds_read_b128 v[80:83], v13 offset:18432
    ds_read_b64_tr_b16 v[60:61], v2 offset:2048
    v_mfma_f32_32x32x16_bf16 v[176:191], v[32:35], v[56:59], v[176:191]
    ds_read_b64_tr_b16 v[62:63], v2 offset:2560
    ds_read_b128 v[84:87], v13 offset:22528
    v_mfma_f32_32x32x16_bf16 v[112:127], v[36:39], v[52:55], v[112:127]
    ds_read_b64_tr_b16 v[64:65], v3 offset:2048
    ds_read_b64_tr_b16 v[66:67], v3 offset:2560
    v_mfma_f32_32x32x16_bf16 v[192:207], v[36:39], v[56:59], v[192:207]
    ds_read_b64_tr_b16 v[68:69], v4 offset:2048
    ds_read_b64_tr_b16 v[70:71], v4 offset:2560
    v_mfma_f32_32x32x16_bf16 v[128:143], v[40:43], v[52:55], v[128:143]
    ds_read_b64_tr_b16 v[72:73], v5 offset:2048
    ds_read_b64_tr_b16 v[74:75], v5 offset:2560
    v_mfma_f32_32x32x16_bf16 v[208:223], v[40:43], v[56:59], v[208:223]
    ds_read_b64_tr_b16 v[76:77], v6 offset:2048
    ds_read_b64_tr_b16 v[78:79], v6 offset:2560
    v_mfma_f32_32x32x16_bf16 v[144:159], v[44:47], v[52:55], v[144:159]
    v_mfma_f32_32x32x16_bf16 v[224:239], v[44:47], v[56:59], v[224:239]
    v_mfma_f32_32x32x16_bf16 v[160:175], v[48:51], v[52:55], v[160:175]
    v_mfma_f32_32x32x16_bf16 v[240:255], v[48:51], v[56:59], v[240:255]
    s_waitcnt lgkmcnt(0)
    v_mfma_f32_32x32x16_bf16 v[96:111], v[60:63], v[80:83], v[96:111]
    s_barrier
    ds_read_b128 v[52:55], v14 offset:18432
    v_subrev_u32 v2, 81920, v2
    ds_read_b64_tr_b16 v[32:33], v2 offset:0
    v_mfma_f32_32x32x16_bf16 v[176:191], v[60:63], v[84:87], v[176:191]
    ds_read_b64_tr_b16 v[34:35], v2 offset:512
    ds_read_b128 v[56:59], v14 offset:22528
    v_mfma_f32_32x32x16_bf16 v[112:127], v[64:67], v[80:83], v[112:127]
    v_subrev_u32 v3, 81920, v3
    ds_read_b64_tr_b16 v[36:37], v3 offset:0
    ds_read_b64_tr_b16 v[38:39], v3 offset:512
    v_mfma_f32_32x32x16_bf16 v[192:207], v[64:67], v[84:87], v[192:207]
    v_subrev_u32 v4, 81920, v4
    ds_read_b64_tr_b16 v[40:41], v4 offset:0
    ds_read_b64_tr_b16 v[42:43], v4 offset:512
    v_mfma_f32_32x32x16_bf16 v[128:143], v[68:71], v[80:83], v[128:143]
    v_subrev_u32 v5, 81920, v5
    ds_read_b64_tr_b16 v[44:45], v5 offset:0
    ds_read_b64_tr_b16 v[46:47], v5 offset:512
    v_mfma_f32_32x32x16_bf16 v[208:223], v[68:71], v[84:87], v[208:223]
    v_subrev_u32 v6, 81920, v6
    ds_read_b64_tr_b16 v[48:49], v6 offset:0
    ds_read_b64_tr_b16 v[50:51], v6 offset:512
    v_mfma_f32_32x32x16_bf16 v[144:159], v[72:75], v[80:83], v[144:159]
    v_mfma_f32_32x32x16_bf16 v[224:239], v[72:75], v[84:87], v[224:239]
    v_mfma_f32_32x32x16_bf16 v[160:175], v[76:79], v[80:83], v[160:175]
    v_mfma_f32_32x32x16_bf16 v[240:255], v[76:79], v[84:87], v[240:255]
    s_waitcnt lgkmcnt(0)
    v_mfma_f32_32x32x16_bf16 v[96:111], v[32:35], v[52:55], v[96:111]
    ds_read_b128 v[80:83], v15 offset:18432
    ds_read_b64_tr_b16 v[60:61], v2 offset:2048
    v_mfma_f32_32x32x16_bf16 v[176:191], v[32:35], v[56:59], v[176:191]
    ds_read_b64_tr_b16 v[62:63], v2 offset:2560
    ds_read_b128 v[84:87], v15 offset:22528
    v_mfma_f32_32x32x16_bf16 v[112:127], v[36:39], v[52:55], v[112:127]
    ds_read_b64_tr_b16 v[64:65], v3 offset:2048
    ds_read_b64_tr_b16 v[66:67], v3 offset:2560
    v_mfma_f32_32x32x16_bf16 v[192:207], v[36:39], v[56:59], v[192:207]
    ds_read_b64_tr_b16 v[68:69], v4 offset:2048
    ds_read_b64_tr_b16 v[70:71], v4 offset:2560
    v_mfma_f32_32x32x16_bf16 v[128:143], v[40:43], v[52:55], v[128:143]
    ds_read_b64_tr_b16 v[72:73], v5 offset:2048
    ds_read_b64_tr_b16 v[74:75], v5 offset:2560
    v_mfma_f32_32x32x16_bf16 v[208:223], v[40:43], v[56:59], v[208:223]
    ds_read_b64_tr_b16 v[76:77], v6 offset:2048
    ds_read_b64_tr_b16 v[78:79], v6 offset:2560
    v_mfma_f32_32x32x16_bf16 v[144:159], v[44:47], v[52:55], v[144:159]
    v_mfma_f32_32x32x16_bf16 v[224:239], v[44:47], v[56:59], v[224:239]
    v_mfma_f32_32x32x16_bf16 v[160:175], v[48:51], v[52:55], v[160:175]
    v_mfma_f32_32x32x16_bf16 v[240:255], v[48:51], v[56:59], v[240:255]
    s_waitcnt lgkmcnt(0)
    v_mfma_f32_32x32x16_bf16 v[96:111], v[60:63], v[80:83], v[96:111]
    s_barrier
    ds_read_b64 v[52:53], v21 offset:0
    ds_read_b64 v[54:55], v21 offset:256
    v_mfma_f32_32x32x16_bf16 v[176:191], v[60:63], v[84:87], v[176:191]
    ds_read_b64 v[32:33], v16
    v_mov_b32 v34, 0
    v_mov_b32 v35, 0
    ds_read_b64 v[36:37], v17
    v_mov_b32 v38, 0
    v_mov_b32 v39, 0
    v_mfma_f32_32x32x16_bf16 v[112:127], v[64:67], v[80:83], v[112:127]
    ds_read_b64 v[40:41], v18
    v_mov_b32 v42, 0
    v_mov_b32 v43, 0
    ds_read_b64 v[44:45], v19
    v_mov_b32 v46, 0
    v_mov_b32 v47, 0
    v_mfma_f32_32x32x16_bf16 v[192:207], v[64:67], v[84:87], v[192:207]
    ds_read_b64 v[48:49], v20
    v_mov_b32 v50, 0
    v_mov_b32 v51, 0
    v_mfma_f32_32x32x16_bf16 v[128:143], v[68:71], v[80:83], v[128:143]
    v_mfma_f32_32x32x16_bf16 v[208:223], v[68:71], v[84:87], v[208:223]
    v_mfma_f32_32x32x16_bf16 v[144:159], v[72:75], v[80:83], v[144:159]
    v_mfma_f32_32x32x16_bf16 v[224:239], v[72:75], v[84:87], v[224:239]
    v_mfma_f32_32x32x16_bf16 v[160:175], v[76:79], v[80:83], v[160:175]
    v_mfma_f32_32x32x16_bf16 v[240:255], v[76:79], v[84:87], v[240:255]
    s_setprio 2
    s_waitcnt lgkmcnt(0)
    v_cmp_gt_u32 vcc, 32, v0
    s_nop 1
    v_cndmask_b32 v88, 0, v52, vcc
    v_cndmask_b32 v92, 0, v54, vcc
    v_and_b32 v89, 0xffff, v88
    v_and_b32 v93, 0xffff, v92
    v_mul_f32 v56, v53, v53
    v_mul_f32 v57, v55, v55
    s_lshl_b32 s60, s50, 2
    s_lshl_b32 s3, s47, 1
    s_add_u32 s60, s60, s3
    s_mul_i32 s60, s60, 144
    s_add_u32 s61, s60, 144
    v_mfma_f32_32x32x16_bf16 v[96:111], v[32:35], v[88:91], v[96:111]
    v_mfma_f32_32x32x16_bf16 v[176:191], v[32:35], v[92:95], v[176:191]
    v_mfma_f32_32x32x16_bf16 v[112:127], v[36:39], v[88:91], v[112:127]
    v_mfma_f32_32x32x16_bf16 v[192:207], v[36:39], v[92:95], v[192:207]
    v_mfma_f32_32x32x16_bf16 v[128:143], v[40:43], v[88:91], v[128:143]
    v_mfma_f32_32x32x16_bf16 v[208:223], v[40:43], v[92:95], v[208:223]
    v_mfma_f32_32x32x16_bf16 v[144:159], v[44:47], v[88:91], v[144:159]
    v_mfma_f32_32x32x16_bf16 v[224:239], v[44:47], v[92:95], v[224:239]
    v_mfma_f32_32x32x16_bf16 v[160:175], v[48:51], v[88:91], v[160:175]
    v_mfma_f32_32x32x16_bf16 v[240:255], v[48:51], v[92:95], v[240:255]
    s_cmp_lg_u32 s48, 0
    s_cbranch_scc1 ep_B
    v_lshrrev_b32 v24, 5, v0
    v_mul_u32_u24 v24, 2560, v24
    v_bfe_u32 v25, v0, 4, 1
    v_and_b32 v26, 15, v0
    s_mul_i32 s3, s49, 73728
    v_mul_u32_u24 v27, 1280, v25
    v_lshlrev_b32 v28, 4, v26
    v_add_u32 v27, v27, v24
    v_add_u32 v27, v27, v28
    s_lshl_b32 s62, s47, 9
    s_add_u32 s62, s62, s3
    s_add_u32 s62, s62, 128
    v_add_u32 v27, s62, v27
    v_mul_u32_u24 v28, 640, v25
    v_lshlrev_b32 v29, 3, v26
    v_add_u32 v28, v28, v24
    v_add_u32 v28, v28, v29
    s_lshl_b32 s62, s47, 8
    s_add_u32 s62, s62, s3
    s_add_u32 s62, s62, 30784
    v_add_u32 v28, s62, v28
    v_pk_mul_f32 v[96:97], v[96:97], v[52:53] op_sel:[0,1] op_sel_hi:[1,1]
    v_pk_mul_f32 v[98:99], v[98:99], v[52:53] op_sel:[0,1] op_sel_hi:[1,1]
    v_pk_mul_f32 v[100:101], v[100:101], v[52:53] op_sel:[0,1] op_sel_hi:[1,1]
    v_pk_mul_f32 v[102:103], v[102:103], v[52:53] op_sel:[0,1] op_sel_hi:[1,1]
    v_pk_mul_f32 v[104:105], v[104:105], v[52:53] op_sel:[0,1] op_sel_hi:[1,1]
    v_pk_mul_f32 v[106:107], v[106:107], v[52:53] op_sel:[0,1] op_sel_hi:[1,1]
    v_pk_mul_f32 v[108:109], v[108:109], v[52:53] op_sel:[0,1] op_sel_hi:[1,1]
    v_pk_mul_f32 v[110:111], v[110:111], v[52:53] op_sel:[0,1] op_sel_hi:[1,1]
    v_cvt_pk_bf16_f32 v96, v96, v97
    v_cvt_pk_bf16_f32 v97, v98, v99
    v_cvt_pk_bf16_f32 v98, v100, v101
    v_cvt_pk_bf16_f32 v99, v102, v103
    v_cvt_pk_bf16_f32 v100, v104, v105
    v_cvt_pk_bf16_f32 v101, v106, v107
    v_cvt_pk_bf16_f32 v102, v108, v109
    v_cvt_pk_bf16_f32 v103, v110, v111
    ds_write_b128 v27, v[96:99] offset:20480
    ds_write_b128 v27, v[100:103] offset:57344
    v_pk_mul_f32 v[176:177], v[176:177], v[54:55] op_sel:[0,1] op_sel_hi:[1,1]
    v_pk_mul_f32 v[178:179], v[178:179], v[54:55] op_sel:[0,1] op_sel_hi:[1,1]
    v_pk_mul_f32 v[180:181], v[180:181], v[54:55] op_sel:[0,1] op_sel_hi:[1,1]
    v_pk_mul_f32 v[182:183], v[182:183], v[54:55] op_sel:[0,1] op_sel_hi:[1,1]
    v_pk_mul_f32 v[184:185], v[184:185], v[54:55] op_sel:[0,1] op_sel_hi:[1,1]
    v_pk_mul_f32 v[186:187], v[186:187], v[54:55] op_sel:[0,1] op_sel_hi:[1,1]
    v_pk_mul_f32 v[188:189], v[188:189], v[54:55] op_sel:[0,1] op_sel_hi:[1,1]
    v_pk_mul_f32 v[190:191], v[190:191], v[54:55] op_sel:[0,1] op_sel_hi:[1,1]
    v_cvt_pk_bf16_f32 v176, v176, v177
    v_cvt_pk_bf16_f32 v177, v178, v179
    v_cvt_pk_bf16_f32 v178, v180, v181
    v_cvt_pk_bf16_f32 v179, v182, v183
    v_cvt_pk_bf16_f32 v180, v184, v185
    v_cvt_pk_bf16_f32 v181, v186, v187
    v_cvt_pk_bf16_f32 v182, v188, v189
    v_cvt_pk_bf16_f32 v183, v190, v191
    ds_write_b128 v27, v[176:179] offset:20736
    ds_write_b128 v27, v[180:183] offset:57600
    s_bfe_u32 s89, s96, 0x40000
    s_lshl_b32 s89, s89, 11
    s_add_u32 s89, s89, s80
    buffer_load_dwordx4 v[176:179], v22, s[20:23], s89 offen offset:0 sc1
    buffer_load_dwordx4 v[180:183], v22, s[20:23], s89 offen offset:1024 sc1
    v_pk_mul_f32 v[112:113], v[112:113], v[52:53] op_sel:[0,1] op_sel_hi:[1,1]
    v_pk_mul_f32 v[114:115], v[114:115], v[52:53] op_sel:[0,1] op_sel_hi:[1,1]
    v_pk_mul_f32 v[116:117], v[116:117], v[52:53] op_sel:[0,1] op_sel_hi:[1,1]
    v_pk_mul_f32 v[118:119], v[118:119], v[52:53] op_sel:[0,1] op_sel_hi:[1,1]
    v_pk_mul_f32 v[120:121], v[120:121], v[52:53] op_sel:[0,1] op_sel_hi:[1,1]
    v_pk_mul_f32 v[122:123], v[122:123], v[52:53] op_sel:[0,1] op_sel_hi:[1,1]
    v_pk_mul_f32 v[124:125], v[124:125], v[52:53] op_sel:[0,1] op_sel_hi:[1,1]
    v_pk_mul_f32 v[126:127], v[126:127], v[52:53] op_sel:[0,1] op_sel_hi:[1,1]
    v_cvt_pk_bf16_f32 v112, v112, v113
    v_cvt_pk_bf16_f32 v113, v114, v115
    v_cvt_pk_bf16_f32 v114, v116, v117
    v_cvt_pk_bf16_f32 v115, v118, v119
    v_cvt_pk_bf16_f32 v116, v120, v121
    v_cvt_pk_bf16_f32 v117, v122, v123
    v_cvt_pk_bf16_f32 v118, v124, v125
    v_cvt_pk_bf16_f32 v119, v126, v127
    ds_write_b128 v27, v[112:115] offset:25600
    ds_write_b128 v27, v[116:119] offset:62464
    s_bfe_u32 s89, s96, 0x40004
    s_lshl_b32 s89, s89, 11
    s_add_u32 s89, s89, s80
    buffer_load_dwordx4 v[184:187], v22, s[20:23], s89 offen offset:0 sc1
    buffer_load_dwordx4 v[188:191], v22, s[20:23], s89 offen offset:1024 sc1
    v_pk_mul_f32 v[192:193], v[192:193], v[54:55] op_sel:[0,1] op_sel_hi:[1,1]
    v_pk_mul_f32 v[194:195], v[194:195], v[54:55] op_sel:[0,1] op_sel_hi:[1,1]
    v_pk_mul_f32 v[196:197], v[196:197], v[54:55] op_sel:[0,1] op_sel_hi:[1,1]
    v_pk_mul_f32 v[198:199], v[198:199], v[54:55] op_sel:[0,1] op_sel_hi:[1,1]
    v_pk_mul_f32 v[200:201], v[200:201], v[54:55] op_sel:[0,1] op_sel_hi:[1,1]
    v_pk_mul_f32 v[202:203], v[202:203], v[54:55] op_sel:[0,1] op_sel_hi:[1,1]
    v_pk_mul_f32 v[204:205], v[204:205], v[54:55] op_sel:[0,1] op_sel_hi:[1,1]
    v_pk_mul_f32 v[206:207], v[206:207], v[54:55] op_sel:[0,1] op_sel_hi:[1,1]
    v_cvt_pk_bf16_f32 v192, v192, v193
    v_cvt_pk_bf16_f32 v193, v194, v195
    v_cvt_pk_bf16_f32 v194, v196, v197
    v_cvt_pk_bf16_f32 v195, v198, v199
    v_cvt_pk_bf16_f32 v196, v200, v201
    v_cvt_pk_bf16_f32 v197, v202, v203
    v_cvt_pk_bf16_f32 v198, v204, v205
    v_cvt_pk_bf16_f32 v199, v206, v207
    ds_write_b128 v27, v[192:195] offset:25856
    ds_write_b128 v27, v[196:199] offset:62720
    s_bfe_u32 s89, s96, 0x40008
    s_lshl_b32 s89, s89, 11
    s_add_u32 s89, s89, s80
    buffer_load_dwordx4 v[112:115], v22, s[20:23], s89 offen offset:0 sc1
    buffer_load_dwordx4 v[116:119], v22, s[20:23], s89 offen offset:1024 sc1
    v_pk_mul_f32 v[128:129], v[128:129], v[52:53] op_sel:[0,1] op_sel_hi:[1,1]
    v_pk_mul_f32 v[130:131], v[130:131], v[52:53] op_sel:[0,1] op_sel_hi:[1,1]
    v_pk_mul_f32 v[132:133], v[132:133], v[52:53] op_sel:[0,1] op_sel_hi:[1,1]
    v_pk_mul_f32 v[134:135], v[134:135], v[52:53] op_sel:[0,1] op_sel_hi:[1,1]
    v_pk_mul_f32 v[136:137], v[136:137], v[52:53] op_sel:[0,1] op_sel_hi:[1,1]
    v_pk_mul_f32 v[138:139], v[138:139], v[52:53] op_sel:[0,1] op_sel_hi:[1,1]
    v_pk_mul_f32 v[140:141], v[140:141], v[52:53] op_sel:[0,1] op_sel_hi:[1,1]
    v_pk_mul_f32 v[142:143], v[142:143], v[52:53] op_sel:[0,1] op_sel_hi:[1,1]
    v_cvt_pk_bf16_f32 v128, v128, v129
    v_cvt_pk_bf16_f32 v129, v130, v131
    v_cvt_pk_bf16_f32 v130, v132, v133
    v_cvt_pk_bf16_f32 v131, v134, v135
    v_cvt_pk_bf16_f32 v132, v136, v137
    v_cvt_pk_bf16_f32 v133, v138, v139
    v_cvt_pk_bf16_f32 v134, v140, v141
    v_cvt_pk_bf16_f32 v135, v142, v143
    ds_write_b64 v28, v[128:129] offset:0
    ds_write_b64 v28, v[130:131] offset:1280
    ds_write_b64 v28, v[132:133] offset:36864
    ds_write_b64 v28, v[134:135] offset:38144
    s_bfe_u32 s89, s96, 0x4000c
    s_lshl_b32 s89, s89, 11
    s_add_u32 s89, s89, s80
    buffer_load_dwordx4 v[120:123], v22, s[20:23], s89 offen offset:0 sc1
    buffer_load_dwordx4 v[124:127], v22, s[20:23], s89 offen offset:1024 sc1
    v_pk_mul_f32 v[208:209], v[208:209], v[54:55] op_sel:[0,1] op_sel_hi:[1,1]
    v_pk_mul_f32 v[210:211], v[210:211], v[54:55] op_sel:[0,1] op_sel_hi:[1,1]
    v_pk_mul_f32 v[212:213], v[212:213], v[54:55] op_sel:[0,1] op_sel_hi:[1,1]
    v_pk_mul_f32 v[214:215], v[214:215], v[54:55] op_sel:[0,1] op_sel_hi:[1,1]
    v_pk_mul_f32 v[216:217], v[216:217], v[54:55] op_sel:[0,1] op_sel_hi:[1,1]
    v_pk_mul_f32 v[218:219], v[218:219], v[54:55] op_sel:[0,1] op_sel_hi:[1,1]
    v_pk_mul_f32 v[220:221], v[220:221], v[54:55] op_sel:[0,1] op_sel_hi:[1,1]
    v_pk_mul_f32 v[222:223], v[222:223], v[54:55] op_sel:[0,1] op_sel_hi:[1,1]
    v_cvt_pk_bf16_f32 v208, v208, v209
    v_cvt_pk_bf16_f32 v209, v210, v211
    v_cvt_pk_bf16_f32 v210, v212, v213
    v_cvt_pk_bf16_f32 v211, v214, v215
    v_cvt_pk_bf16_f32 v212, v216, v217
    v_cvt_pk_bf16_f32 v213, v218, v219
    v_cvt_pk_bf16_f32 v214, v220, v221
    v_cvt_pk_bf16_f32 v215, v222, v223
    ds_write_b64 v28, v[208:209] offset:128
    ds_write_b64 v28, v[210:211] offset:1408
    ds_write_b64 v28, v[212:213] offset:36992
    ds_write_b64 v28, v[214:215] offset:38272
    s_bfe_u32 s89, s96, 0x40010
    s_lshl_b32 s89, s89, 11
    s_add_u32 s89, s89, s80
    buffer_load_dwordx4 v[192:195], v22, s[20:23], s89 offen offset:0 sc1
    buffer_load_dwordx4 v[196:199], v22, s[20:23], s89 offen offset:1024 sc1
    v_pk_mul_f32 v[144:145], v[144:145], v[152:153]
    v_pk_mul_f32 v[146:147], v[146:147], v[154:155]
    v_pk_mul_f32 v[148:149], v[148:149], v[156:157]
    v_pk_mul_f32 v[150:151], v[150:151], v[158:159]
    v_pk_mul_f32 v[144:145], v[144:145], v[56:57] op_sel:[0,0] op_sel_hi:[1,0]
    v_pk_mul_f32 v[146:147], v[146:147], v[56:57] op_sel:[0,0] op_sel_hi:[1,0]
    v_pk_mul_f32 v[148:149], v[148:149], v[56:57] op_sel:[0,0] op_sel_hi:[1,0]
    v_pk_mul_f32 v[150:151], v[150:151], v[56:57] op_sel:[0,0] op_sel_hi:[1,0]
    v_cvt_pk_bf16_f32 v152, v144, v145
    v_cvt_pk_bf16_f32 v153, v146, v147
    v_cvt_pk_bf16_f32 v154, v148, v149
    v_cvt_pk_bf16_f32 v155, v150, v151
    s_add_u32 s3, s60, s66
    s_lshl_b32 s3, s3, 10
    s_add_u32 s3, s3, 65536
    buffer_store_dwordx4 v[152:155], v22, s[20:23], s3 offen sc1
    s_bfe_u32 s89, s96, 0x40014
    s_lshl_b32 s89, s89, 11
    s_add_u32 s89, s89, s80
    buffer_load_dwordx4 v[200:203], v22, s[20:23], s89 offen offset:0 sc1
    buffer_load_dwordx4 v[204:207], v22, s[20:23], s89 offen offset:1024 sc1
    v_pk_mul_f32 v[224:225], v[224:225], v[232:233]
    v_pk_mul_f32 v[226:227], v[226:227], v[234:235]
    v_pk_mul_f32 v[228:229], v[228:229], v[236:237]
    v_pk_mul_f32 v[230:231], v[230:231], v[238:239]
    v_pk_mul_f32 v[224:225], v[224:225], v[56:57] op_sel:[0,1] op_sel_hi:[1,1]
    v_pk_mul_f32 v[226:227], v[226:227], v[56:57] op_sel:[0,1] op_sel_hi:[1,1]
    v_pk_mul_f32 v[228:229], v[228:229], v[56:57] op_sel:[0,1] op_sel_hi:[1,1]
    v_pk_mul_f32 v[230:231], v[230:231], v[56:57] op_sel:[0,1] op_sel_hi:[1,1]
    v_cvt_pk_bf16_f32 v232, v224, v225
    v_cvt_pk_bf16_f32 v233, v226, v227
    v_cvt_pk_bf16_f32 v234, v228, v229
    v_cvt_pk_bf16_f32 v235, v230, v231
    s_add_u32 s3, s61, s66
    s_lshl_b32 s3, s3, 10
    s_add_u32 s3, s3, 65536
    buffer_store_dwordx4 v[232:235], v22, s[20:23], s3 offen sc1
    s_bfe_u32 s89, s96, 0x40018
    s_lshl_b32 s89, s89, 11
    s_add_u32 s89, s89, s80
    buffer_load_dwordx4 v[128:131], v22, s[20:23], s89 offen offset:0 sc1
    buffer_load_dwordx4 v[132:135], v22, s[20:23], s89 offen offset:1024 sc1
    v_pk_mul_f32 v[160:161], v[160:161], v[168:169]
    v_pk_mul_f32 v[162:163], v[162:163], v[170:171]
    v_pk_mul_f32 v[164:165], v[164:165], v[172:173]
    v_pk_mul_f32 v[166:167], v[166:167], v[174:175]
    v_pk_mul_f32 v[160:161], v[160:161], v[56:57] op_sel:[0,0] op_sel_hi:[1,0]
    v_pk_mul_f32 v[162:163], v[162:163], v[56:57] op_sel:[0,0] op_sel_hi:[1,0]
    v_pk_mul_f32 v[164:165], v[164:165], v[56:57] op_sel:[0,0] op_sel_hi:[1,0]
    v_pk_mul_f32 v[166:167], v[166:167], v[56:57] op_sel:[0,0] op_sel_hi:[1,0]
    v_cvt_pk_bf16_f32 v168, v160, v161
    v_cvt_pk_bf16_f32 v169, v162, v163
    v_cvt_pk_bf16_f32 v170, v164, v165
    v_cvt_pk_bf16_f32 v171, v166, v167
    s_add_u32 s3, s60, s67
    s_lshl_b32 s3, s3, 10
    s_add_u32 s3, s3, 65536
    buffer_store_dwordx4 v[168:171], v22, s[20:23], s3 offen sc1
    s_bfe_u32 s89, s96, 0x4001c
    s_lshl_b32 s89, s89, 11
    s_add_u32 s89, s89, s80
    buffer_load_dwordx4 v[136:139], v22, s[20:23], s89 offen offset:0 sc1
    buffer_load_dwordx4 v[140:143], v22, s[20:23], s89 offen offset:1024 sc1
    v_pk_mul_f32 v[240:241], v[240:241], v[248:249]
    v_pk_mul_f32 v[242:243], v[242:243], v[250:251]
    v_pk_mul_f32 v[244:245], v[244:245], v[252:253]
    v_pk_mul_f32 v[246:247], v[246:247], v[254:255]
    v_pk_mul_f32 v[240:241], v[240:241], v[56:57] op_sel:[0,1] op_sel_hi:[1,1]
    v_pk_mul_f32 v[242:243], v[242:243], v[56:57] op_sel:[0,1] op_sel_hi:[1,1]
    v_pk_mul_f32 v[244:245], v[244:245], v[56:57] op_sel:[0,1] op_sel_hi:[1,1]
    v_pk_mul_f32 v[246:247], v[246:247], v[56:57] op_sel:[0,1] op_sel_hi:[1,1]
    v_cvt_pk_bf16_f32 v248, v240, v241
    v_cvt_pk_bf16_f32 v249, v242, v243
    v_cvt_pk_bf16_f32 v250, v244, v245
    v_cvt_pk_bf16_f32 v251, v246, v247
    s_add_u32 s3, s61, s67
    s_lshl_b32 s3, s3, 10
    s_add_u32 s3, s3, 65536
    buffer_store_dwordx4 v[248:251], v22, s[20:23], s3 offen sc1
    s_bfe_u32 s89, s97, 0x40000
    s_lshl_b32 s89, s89, 11
    s_add_u32 s89, s89, s80
    buffer_load_dwordx4 v[208:211], v22, s[20:23], s89 offen offset:0 sc1
    buffer_load_dwordx4 v[212:215], v22, s[20:23], s89 offen offset:1024 sc1
    s_waitcnt lgkmcnt(0)
    s_bfe_u32 s89, s97, 0x40004
    s_lshl_b32 s89, s89, 11
    s_add_u32 s89, s89, s80
    buffer_load_dwordx4 v[216:219], v22, s[20:23], s89 offen offset:0 sc1
    buffer_load_dwordx4 v[220:223], v22, s[20:23], s89 offen offset:1024 sc1
    s_bfe_u32 s89, s98, 0x80000
    s_lshl_b32 s89, s89, 11
    s_add_u32 s89, s89, s82
    buffer_load_dwordx4 v[144:147], v22, s[20:23], s89 offen offset:0 sc1
    buffer_load_dwordx4 v[148:151], v22, s[20:23], s89 offen offset:1024 sc1
attn:
    s_barrier
    buffer_load_dword v18, off, s[20:23], s87 sc1
    s_and_b32 s47, s46, 3
    s_lshr_b32 s49, s46, 2
    v_lshrrev_b32 v1, 5, v0
    s_lshl_b32 s3, s49, 1
    v_add_u32 v1, s3, v1
    v_lshlrev_b32 v20, 4, v1
    v_and_b32 v92, 15, v0
    v_add_u32 v20, v20, v92
    v_bfe_u32 v93, v0, 4, 1
    v_mul_u32_u24 v94, 1280, v93
    v_lshlrev_b32 v21, 4, v20
    v_add_u32 v21, v21, v94
    s_mul_i32 s3, s47, 36864
    v_add_u32 v21, s3, v21
    ds_read_b128 v[24:27], v21 offset:20608
    ds_read_b128 v[28:31], v21 offset:23168
    ds_read_b128 v[32:35], v21 offset:25600
    ds_read_b128 v[36:39], v21 offset:28160
    ds_read_b128 v[40:43], v21 offset:25664
    ds_read_b128 v[44:47], v21 offset:28224
    ds_read_b128 v[48:51], v21 offset:25728
    ds_read_b128 v[52:55], v21 offset:28288
    v_lshlrev_b32 v1, 4, v1
    v_and_b32 v92, 3, v0
    v_lshlrev_b32 v92, 2, v92
    v_add_u32 v1, v1, v92
    v_bfe_u32 v92, v0, 2, 2
    v_add_u32 v1, v1, v92
    v_lshlrev_b32 v1, 3, v1
    v_mul_u32_u24 v92, 640, v93
    v_add_u32 v1, v1, v92
    s_add_u32 s3, s3, 30720
    v_add_u32 v1, s3, v1
    ds_read_b64_tr_b16 v[56:57], v1 offset:0
    ds_read_b64_tr_b16 v[58:59], v1 offset:1280
    ds_read_b64_tr_b16 v[60:61], v1 offset:2560
    ds_read_b64_tr_b16 v[62:63], v1 offset:3840
    ds_read_b64_tr_b16 v[64:65], v1 offset:32
    ds_read_b64_tr_b16 v[66:67], v1 offset:1312
    ds_read_b64_tr_b16 v[68:69], v1 offset:2592
    ds_read_b64_tr_b16 v[70:71], v1 offset:3872
    ds_read_b64_tr_b16 v[72:73], v1 offset:64
    ds_read_b64_tr_b16 v[74:75], v1 offset:1344
    ds_read_b64_tr_b16 v[76:77], v1 offset:2624
    ds_read_b64_tr_b16 v[78:79], v1 offset:3904
    v_mov_b32 v92, 0
    v_mov_b32 v93, 0
    s_cmp_lg_u32 s50, 0
    s_cbranch_scc1 at_nomask
    v_mov_b32 v94, 0xf149f2ca
    v_cmp_gt_u32 vcc, 8, v20
    s_nop 1
    v_cndmask_b32 v92, 0, v94, vcc
    v_cmp_gt_u32 vcc, 4, v20
    s_nop 1
    v_cndmask_b32 v93, 0, v94, vcc
at_nomask:
    v_mov_b32 v80, v92
    v_mov_b32 v84, v93
    v_mov_b32 v81, v92
    v_mov_b32 v85, v93
    v_mov_b32 v82, v92
    v_mov_b32 v86, v93
    v_mov_b32 v83, v92
    v_mov_b32 v87, v93
    s_cmp_lt_u32 s46, 4
    s_cbranch_scc0 at_tl1
    s_bfe_u32 s89, s98, 0x80008
    s_lshl_b32 s89, s89, 11
    s_add_u32 s89, s89, s82
    buffer_load_dwordx4 v[152:155], v22, s[20:23], s89 offen offset:0 sc1
    buffer_load_dwordx4 v[156:159], v22, s[20:23], s89 offen offset:1024 sc1
    s_bfe_u32 s89, s98, 0x80010
    s_lshl_b32 s89, s89, 11
    s_add_u32 s89, s89, s82
    buffer_load_dwordx4 v[224:227], v22, s[20:23], s89 offen offset:0 sc1
    buffer_load_dwordx4 v[228:231], v22, s[20:23], s89 offen offset:1024 sc1
at_tl1:
    s_waitcnt lgkmcnt(12)
    v_mfma_f32_4x4x4_16b_bf16 v[80:83], v[32:33], v[24:25], v[80:83]
    v_mfma_f32_4x4x4_16b_bf16 v[84:87], v[40:41], v[24:25], v[84:87]
    v_mfma_f32_4x4x4_16b_bf16 v[88:91], v[48:49], v[24:25], 0
    v_mfma_f32_4x4x4_16b_bf16 v[80:83], v[34:35], v[26:27], v[80:83]
    v_mfma_f32_4x4x4_16b_bf16 v[84:87], v[42:43], v[26:27], v[84:87]
    v_mfma_f32_4x4x4_16b_bf16 v[88:91], v[50:51], v[26:27], v[88:91]
    v_mfma_f32_4x4x4_16b_bf16 v[80:83], v[36:37], v[28:29], v[80:83]
    v_mfma_f32_4x4x4_16b_bf16 v[84:87], v[44:45], v[28:29], v[84:87]
    v_mfma_f32_4x4x4_16b_bf16 v[88:91], v[52:53], v[28:29], v[88:91]
    v_mfma_f32_4x4x4_16b_bf16 v[80:83], v[38:39], v[30:31], v[80:83]
    v_mfma_f32_4x4x4_16b_bf16 v[84:87], v[46:47], v[30:31], v[84:87]
    v_mfma_f32_4x4x4_16b_bf16 v[88:91], v[54:55], v[30:31], v[88:91]
    s_mov_b32 s62, 0x11111111
    s_mov_b32 s63, 0x11111111
    s_mov_b32 s64, 0x33333333
    s_mov_b32 s65, 0x33333333
    s_mov_b32 s66, 0x77777777
    s_mov_b32 s67, 0x77777777
    s_mov_b32 s61, 0x3eb8aa3b
    s_cmp_lt_u32 s46, 4
    s_cbranch_scc0 at_tl2
    s_bfe_u32 s89, s98, 0x80018
    s_lshl_b32 s89, s89, 11
    s_add_u32 s89, s89, s82
    buffer_load_dwordx4 v[232:235], v22, s[20:23], s89 offen offset:0 sc1
    buffer_load_dwordx4 v[236:239], v22, s[20:23], s89 offen offset:1024 sc1
    s_bfe_u32 s89, s99, 0x80000
    s_lshl_b32 s89, s89, 11
    s_add_u32 s89, s89, s82
    buffer_load_dwordx4 v[160:163], v22, s[20:23], s89 offen offset:0 sc1
    buffer_load_dwordx4 v[164:167], v22, s[20:23], s89 offen offset:1024 sc1
at_tl2:
    v_cndmask_b32 v89, v89, v81, s[62:63]
    v_cndmask_b32 v90, v90, v82, s[64:65]
    v_cndmask_b32 v91, v91, v83, s[66:67]
    v_max3_f32 v92, v88, v89, v90
    v_max3_f32 v93, v91, v84, v85
    v_max3_f32 v92, v92, v86, v87
    v_max_f32 v92, v92, v93
    v_mul_f32 v92, s61, v92
    v_fma_f32 v88, s61, v88, -v92
    v_fma_f32 v89, s61, v89, -v92
    v_fma_f32 v90, s61, v90, -v92
    v_fma_f32 v91, s61, v91, -v92
    v_fma_f32 v84, s61, v84, -v92
    v_fma_f32 v85, s61, v85, -v92
    v_fma_f32 v86, s61, v86, -v92
    v_fma_f32 v87, s61, v87, -v92
    v_exp_f32 v88, v88
    v_exp_f32 v89, v89
    v_exp_f32 v90, v90
    v_exp_f32 v91, v91
    v_exp_f32 v84, v84
    v_exp_f32 v85, v85
    v_exp_f32 v86, v86
    v_exp_f32 v87, v87
    s_cmp_lt_u32 s46, 4
    s_cbranch_scc0 at_tl3
    s_bfe_u32 s89, s99, 0x80008
    s_lshl_b32 s89, s89, 11
    s_add_u32 s89, s89, s82
    buffer_load_dwordx4 v[168:171], v22, s[20:23], s89 offen offset:0 sc1
    buffer_load_dwordx4 v[172:175], v22, s[20:23], s89 offen offset:1024 sc1
    s_bfe_u32 s89, s99, 0x80010
    s_lshl_b32 s89, s89, 11
    s_add_u32 s89, s89, s82
    buffer_load_dwordx4 v[240:243], v22, s[20:23], s89 offen offset:0 sc1
    buffer_load_dwordx4 v[244:247], v22, s[20:23], s89 offen offset:1024 sc1
at_tl3:
    v_add_f32 v93, v88, v89
    v_add_f32 v94, v90, v91
    v_add_f32 v95, v84, v85
    v_add_f32 v92, v86, v87
    v_add_f32 v93, v93, v94
    v_add_f32 v92, v92, v95
    v_add_f32 v92, v92, v93
    v_rcp_f32 v92, v92
    s_nop 0
    v_mul_f32 v88, v88, v92
    v_mul_f32 v89, v89, v92
    v_mul_f32 v90, v90, v92
    v_mul_f32 v91, v91, v92
    v_mul_f32 v84, v84, v92
    v_mul_f32 v85, v85, v92
    v_mul_f32 v86, v86, v92
    v_mul_f32 v87, v87, v92
    v_cvt_pk_bf16_f32 v24, v88, v89
    v_cvt_pk_bf16_f32 v25, v90, v91
    v_cvt_pk_bf16_f32 v26, v84, v85
    v_cvt_pk_bf16_f32 v27, v86, v87
    v_mov_b32 v92, 0xffff0000
    v_cndmask_b32 v93, 0, v92, s[62:63]
    v_cndmask_b32 v94, 0, v92, s[66:67]
    v_mov_b32 v92, 0xffff
    v_cndmask_b32 v95, 0, v92, s[64:65]
    v_or_b32 v94, v94, v95
    v_and_b32 v28, v24, v93
    v_and_b32 v29, v25, v94
    v_xor_b32 v24, v24, v28
    v_xor_b32 v25, v25, v29
    s_waitcnt lgkmcnt(0)
    s_cmp_lt_u32 s46, 4
    s_cbranch_scc0 at_tl4
    s_bfe_u32 s89, s99, 0x80018
    s_lshl_b32 s89, s89, 11
    s_add_u32 s89, s89, s82
    buffer_load_dwordx4 v[248:251], v22, s[20:23], s89 offen offset:0 sc1
    buffer_load_dwordx4 v[252:255], v22, s[20:23], s89 offen offset:1024 sc1
at_tl4:
    v_mfma_f32_4x4x4_16b_bf16 v[32:35], v[56:57], v[28:29], 0
    v_mfma_f32_4x4x4_16b_bf16 v[36:39], v[58:59], v[28:29], 0
    v_mfma_f32_4x4x4_16b_bf16 v[40:43], v[60:61], v[28:29], 0
    v_mfma_f32_4x4x4_16b_bf16 v[44:47], v[62:63], v[28:29], 0
    v_mfma_f32_4x4x4_16b_bf16 v[32:35], v[64:65], v[26:27], v[32:35]
    v_mfma_f32_4x4x4_16b_bf16 v[36:39], v[66:67], v[26:27], v[36:39]
    v_mfma_f32_4x4x4_16b_bf16 v[40:43], v[68:69], v[26:27], v[40:43]
    v_mfma_f32_4x4x4_16b_bf16 v[44:47], v[70:71], v[26:27], v[44:47]
    v_mfma_f32_4x4x4_16b_bf16 v[32:35], v[72:73], v[24:25], v[32:35]
    v_mfma_f32_4x4x4_16b_bf16 v[36:39], v[74:75], v[24:25], v[36:39]
    v_mfma_f32_4x4x4_16b_bf16 v[40:43], v[76:77], v[24:25], v[40:43]
    v_mfma_f32_4x4x4_16b_bf16 v[44:47], v[78:79], v[24:25], v[44:47]
    s_nop 1
    v_cvt_pk_bf16_f32 v48, v32, v33
    v_cvt_pk_bf16_f32 v49, v34, v35
    v_cvt_pk_bf16_f32 v50, v36, v37
    v_cvt_pk_bf16_f32 v51, v38, v39
    v_cvt_pk_bf16_f32 v52, v40, v41
    v_cvt_pk_bf16_f32 v53, v42, v43
    v_cvt_pk_bf16_f32 v54, v44, v45
    v_cvt_pk_bf16_f32 v55, v46, v47
    v_lshrrev_b32 v92, 5, v0
    s_mov_b32 s3, 147456
    v_mul_lo_u32 v92, v92, s3
    v_and_b32 v93, 31, v0
    v_lshlrev_b32 v93, 4, v93
    v_add_u32 v92, v92, v93
    s_lshl_b32 s3, s50, 2
    s_lshl_b32 s61, s49, 1
    s_add_u32 s3, s3, s61
    s_mul_i32 s3, s3, 144
    s_lshl_b32 s61, s51, 2
    s_add_u32 s3, s3, s61
    s_add_u32 s3, s3, s47
    s_lshl_b32 s3, s3, 10
    s_add_u32 s3, s3, 65536
    buffer_store_dwordx4 v[48:51], v92, s[20:23], s3 offen sc1
    buffer_store_dwordx4 v[52:55], v92, s[20:23], s3 offen offset:512 sc1
    s_waitcnt vmcnt(2)
    s_branch p2_chk
ep_B:
    s_nop 3
    v_pk_mul_f32 v[96:97], v[96:97], v[104:105]
    v_pk_mul_f32 v[98:99], v[98:99], v[106:107]
    v_pk_mul_f32 v[100:101], v[100:101], v[108:109]
    v_pk_mul_f32 v[102:103], v[102:103], v[110:111]
    v_pk_mul_f32 v[96:97], v[96:97], v[56:57] op_sel:[0,0] op_sel_hi:[1,0]
    v_pk_mul_f32 v[98:99], v[98:99], v[56:57] op_sel:[0,0] op_sel_hi:[1,0]
    v_pk_mul_f32 v[100:101], v[100:101], v[56:57] op_sel:[0,0] op_sel_hi:[1,0]
    v_pk_mul_f32 v[102:103], v[102:103], v[56:57] op_sel:[0,0] op_sel_hi:[1,0]
    v_cvt_pk_bf16_f32 v104, v96, v97
    v_cvt_pk_bf16_f32 v105, v98, v99
    v_cvt_pk_bf16_f32 v106, v100, v101
    v_cvt_pk_bf16_f32 v107, v102, v103
    s_add_u32 s3, s60, s63
    s_lshl_b32 s3, s3, 10
    s_add_u32 s3, s3, 65536
    buffer_store_dwordx4 v[104:107], v22, s[20:23], s3 offen sc1
    v_pk_mul_f32 v[176:177], v[176:177], v[184:185]
    v_pk_mul_f32 v[178:179], v[178:179], v[186:187]
    v_pk_mul_f32 v[180:181], v[180:181], v[188:189]
    v_pk_mul_f32 v[182:183], v[182:183], v[190:191]
    v_pk_mul_f32 v[176:177], v[176:177], v[56:57] op_sel:[0,1] op_sel_hi:[1,1]
    v_pk_mul_f32 v[178:179], v[178:179], v[56:57] op_sel:[0,1] op_sel_hi:[1,1]
    v_pk_mul_f32 v[180:181], v[180:181], v[56:57] op_sel:[0,1] op_sel_hi:[1,1]
    v_pk_mul_f32 v[182:183], v[182:183], v[56:57] op_sel:[0,1] op_sel_hi:[1,1]
    v_cvt_pk_bf16_f32 v184, v176, v177
    v_cvt_pk_bf16_f32 v185, v178, v179
    v_cvt_pk_bf16_f32 v186, v180, v181
    v_cvt_pk_bf16_f32 v187, v182, v183
    s_add_u32 s3, s61, s63
    s_lshl_b32 s3, s3, 10
    s_add_u32 s3, s3, 65536
    buffer_store_dwordx4 v[184:187], v22, s[20:23], s3 offen sc1
    s_bfe_u32 s89, s96, 0x40000
    s_lshl_b32 s89, s89, 11
    s_add_u32 s89, s89, s80
    buffer_load_dwordx4 v[176:179], v22, s[20:23], s89 offen offset:0 sc1
    v_pk_mul_f32 v[112:113], v[112:113], v[120:121]
    v_pk_mul_f32 v[114:115], v[114:115], v[122:123]
    v_pk_mul_f32 v[116:117], v[116:117], v[124:125]
    v_pk_mul_f32 v[118:119], v[118:119], v[126:127]
    v_pk_mul_f32 v[112:113], v[112:113], v[56:57] op_sel:[0,0] op_sel_hi:[1,0]
    v_pk_mul_f32 v[114:115], v[114:115], v[56:57] op_sel:[0,0] op_sel_hi:[1,0]
    v_pk_mul_f32 v[116:117], v[116:117], v[56:57] op_sel:[0,0] op_sel_hi:[1,0]
    v_pk_mul_f32 v[118:119], v[118:119], v[56:57] op_sel:[0,0] op_sel_hi:[1,0]
    v_cvt_pk_bf16_f32 v120, v112, v113
    v_cvt_pk_bf16_f32 v121, v114, v115
    v_cvt_pk_bf16_f32 v122, v116, v117
    v_cvt_pk_bf16_f32 v123, v118, v119
    s_add_u32 s3, s60, s64
    s_lshl_b32 s3, s3, 10
    s_add_u32 s3, s3, 65536
    buffer_store_dwordx4 v[120:123], v22, s[20:23], s3 offen sc1
    buffer_load_dwordx4 v[180:183], v22, s[20:23], s89 offen offset:1024 sc1
    v_pk_mul_f32 v[192:193], v[192:193], v[200:201]
    v_pk_mul_f32 v[194:195], v[194:195], v[202:203]
    v_pk_mul_f32 v[196:197], v[196:197], v[204:205]
    v_pk_mul_f32 v[198:199], v[198:199], v[206:207]
    v_pk_mul_f32 v[192:193], v[192:193], v[56:57] op_sel:[0,1] op_sel_hi:[1,1]
    v_pk_mul_f32 v[194:195], v[194:195], v[56:57] op_sel:[0,1] op_sel_hi:[1,1]
    v_pk_mul_f32 v[196:197], v[196:197], v[56:57] op_sel:[0,1] op_sel_hi:[1,1]
    v_pk_mul_f32 v[198:199], v[198:199], v[56:57] op_sel:[0,1] op_sel_hi:[1,1]
    v_cvt_pk_bf16_f32 v200, v192, v193
    v_cvt_pk_bf16_f32 v201, v194, v195
    v_cvt_pk_bf16_f32 v202, v196, v197
    v_cvt_pk_bf16_f32 v203, v198, v199
    s_add_u32 s3, s61, s64
    s_lshl_b32 s3, s3, 10
    s_add_u32 s3, s3, 65536
    buffer_store_dwordx4 v[200:203], v22, s[20:23], s3 offen sc1
    s_bfe_u32 s89, s96, 0x40004
    s_lshl_b32 s89, s89, 11
    s_add_u32 s89, s89, s80
    buffer_load_dwordx4 v[184:187], v22, s[20:23], s89 offen offset:0 sc1
    v_pk_mul_f32 v[128:129], v[128:129], v[136:137]
    v_pk_mul_f32 v[130:131], v[130:131], v[138:139]
    v_pk_mul_f32 v[132:133], v[132:133], v[140:141]
    v_pk_mul_f32 v[134:135], v[134:135], v[142:143]
    v_pk_mul_f32 v[128:129], v[128:129], v[56:57] op_sel:[0,0] op_sel_hi:[1,0]
    v_pk_mul_f32 v[130:131], v[130:131], v[56:57] op_sel:[0,0] op_sel_hi:[1,0]
    v_pk_mul_f32 v[132:133], v[132:133], v[56:57] op_sel:[0,0] op_sel_hi:[1,0]
    v_pk_mul_f32 v[134:135], v[134:135], v[56:57] op_sel:[0,0] op_sel_hi:[1,0]
    v_cvt_pk_bf16_f32 v136, v128, v129
    v_cvt_pk_bf16_f32 v137, v130, v131
    v_cvt_pk_bf16_f32 v138, v132, v133
    v_cvt_pk_bf16_f32 v139, v134, v135
    s_add_u32 s3, s60, s65
    s_lshl_b32 s3, s3, 10
    s_add_u32 s3, s3, 65536
    buffer_store_dwordx4 v[136:139], v22, s[20:23], s3 offen sc1
    buffer_load_dwordx4 v[188:191], v22, s[20:23], s89 offen offset:1024 sc1
    v_pk_mul_f32 v[208:209], v[208:209], v[216:217]
    v_pk_mul_f32 v[210:211], v[210:211], v[218:219]
    v_pk_mul_f32 v[212:213], v[212:213], v[220:221]
    v_pk_mul_f32 v[214:215], v[214:215], v[222:223]
    v_pk_mul_f32 v[208:209], v[208:209], v[56:57] op_sel:[0,1] op_sel_hi:[1,1]
    v_pk_mul_f32 v[210:211], v[210:211], v[56:57] op_sel:[0,1] op_sel_hi:[1,1]
    v_pk_mul_f32 v[212:213], v[212:213], v[56:57] op_sel:[0,1] op_sel_hi:[1,1]
    v_pk_mul_f32 v[214:215], v[214:215], v[56:57] op_sel:[0,1] op_sel_hi:[1,1]
    v_cvt_pk_bf16_f32 v216, v208, v209
    v_cvt_pk_bf16_f32 v217, v210, v211
    v_cvt_pk_bf16_f32 v218, v212, v213
    v_cvt_pk_bf16_f32 v219, v214, v215
    s_add_u32 s3, s61, s65
    s_lshl_b32 s3, s3, 10
    s_add_u32 s3, s3, 65536
    buffer_store_dwordx4 v[216:219], v22, s[20:23], s3 offen sc1
    s_bfe_u32 s89, s96, 0x40008
    s_lshl_b32 s89, s89, 11
    s_add_u32 s89, s89, s80
    buffer_load_dwordx4 v[112:115], v22, s[20:23], s89 offen offset:0 sc1
    v_pk_mul_f32 v[144:145], v[144:145], v[152:153]
    v_pk_mul_f32 v[146:147], v[146:147], v[154:155]
    v_pk_mul_f32 v[148:149], v[148:149], v[156:157]
    v_pk_mul_f32 v[150:151], v[150:151], v[158:159]
    v_pk_mul_f32 v[144:145], v[144:145], v[56:57] op_sel:[0,0] op_sel_hi:[1,0]
    v_pk_mul_f32 v[146:147], v[146:147], v[56:57] op_sel:[0,0] op_sel_hi:[1,0]
    v_pk_mul_f32 v[148:149], v[148:149], v[56:57] op_sel:[0,0] op_sel_hi:[1,0]
    v_pk_mul_f32 v[150:151], v[150:151], v[56:57] op_sel:[0,0] op_sel_hi:[1,0]
    v_cvt_pk_bf16_f32 v152, v144, v145
    v_cvt_pk_bf16_f32 v153, v146, v147
    v_cvt_pk_bf16_f32 v154, v148, v149
    v_cvt_pk_bf16_f32 v155, v150, v151
    s_add_u32 s3, s60, s66
    s_lshl_b32 s3, s3, 10
    s_add_u32 s3, s3, 65536
    buffer_store_dwordx4 v[152:155], v22, s[20:23], s3 offen sc1
    buffer_load_dwordx4 v[116:119], v22, s[20:23], s89 offen offset:1024 sc1
    v_pk_mul_f32 v[224:225], v[224:225], v[232:233]
    v_pk_mul_f32 v[226:227], v[226:227], v[234:235]
    v_pk_mul_f32 v[228:229], v[228:229], v[236:237]
    v_pk_mul_f32 v[230:231], v[230:231], v[238:239]
    v_pk_mul_f32 v[224:225], v[224:225], v[56:57] op_sel:[0,1] op_sel_hi:[1,1]
    v_pk_mul_f32 v[226:227], v[226:227], v[56:57] op_sel:[0,1] op_sel_hi:[1,1]
    v_pk_mul_f32 v[228:229], v[228:229], v[56:57] op_sel:[0,1] op_sel_hi:[1,1]
    v_pk_mul_f32 v[230:231], v[230:231], v[56:57] op_sel:[0,1] op_sel_hi:[1,1]
    v_cvt_pk_bf16_f32 v232, v224, v225
    v_cvt_pk_bf16_f32 v233, v226, v227
    v_cvt_pk_bf16_f32 v234, v228, v229
    v_cvt_pk_bf16_f32 v235, v230, v231
    s_add_u32 s3, s61, s66
    s_lshl_b32 s3, s3, 10
    s_add_u32 s3, s3, 65536
    buffer_store_dwordx4 v[232:235], v22, s[20:23], s3 offen sc1
    s_bfe_u32 s89, s96, 0x4000c
    s_lshl_b32 s89, s89, 11
    s_add_u32 s89, s89, s80
    buffer_load_dwordx4 v[120:123], v22, s[20:23], s89 offen offset:0 sc1
    v_pk_mul_f32 v[160:161], v[160:161], v[168:169]
    v_pk_mul_f32 v[162:163], v[162:163], v[170:171]
    v_pk_mul_f32 v[164:165], v[164:165], v[172:173]
    v_pk_mul_f32 v[166:167], v[166:167], v[174:175]
    v_pk_mul_f32 v[160:161], v[160:161], v[56:57] op_sel:[0,0] op_sel_hi:[1,0]
    v_pk_mul_f32 v[162:163], v[162:163], v[56:57] op_sel:[0,0] op_sel_hi:[1,0]
    v_pk_mul_f32 v[164:165], v[164:165], v[56:57] op_sel:[0,0] op_sel_hi:[1,0]
    v_pk_mul_f32 v[166:167], v[166:167], v[56:57] op_sel:[0,0] op_sel_hi:[1,0]
    v_cvt_pk_bf16_f32 v168, v160, v161
    v_cvt_pk_bf16_f32 v169, v162, v163
    v_cvt_pk_bf16_f32 v170, v164, v165
    v_cvt_pk_bf16_f32 v171, v166, v167
    s_add_u32 s3, s60, s67
    s_lshl_b32 s3, s3, 10
    s_add_u32 s3, s3, 65536
    buffer_store_dwordx4 v[168:171], v22, s[20:23], s3 offen sc1
    buffer_load_dwordx4 v[124:127], v22, s[20:23], s89 offen offset:1024 sc1
    v_pk_mul_f32 v[240:241], v[240:241], v[248:249]
    v_pk_mul_f32 v[242:243], v[242:243], v[250:251]
    v_pk_mul_f32 v[244:245], v[244:245], v[252:253]
    v_pk_mul_f32 v[246:247], v[246:247], v[254:255]
    v_pk_mul_f32 v[240:241], v[240:241], v[56:57] op_sel:[0,1] op_sel_hi:[1,1]
    v_pk_mul_f32 v[242:243], v[242:243], v[56:57] op_sel:[0,1] op_sel_hi:[1,1]
    v_pk_mul_f32 v[244:245], v[244:245], v[56:57] op_sel:[0,1] op_sel_hi:[1,1]
    v_pk_mul_f32 v[246:247], v[246:247], v[56:57] op_sel:[0,1] op_sel_hi:[1,1]
    v_cvt_pk_bf16_f32 v248, v240, v241
    v_cvt_pk_bf16_f32 v249, v242, v243
    v_cvt_pk_bf16_f32 v250, v244, v245
    v_cvt_pk_bf16_f32 v251, v246, v247
    s_add_u32 s3, s61, s67
    s_lshl_b32 s3, s3, 10
    s_add_u32 s3, s3, 65536
    buffer_store_dwordx4 v[248:251], v22, s[20:23], s3 offen sc1
    s_bfe_u32 s89, s96, 0x40010
    s_lshl_b32 s89, s89, 11
    s_add_u32 s89, s89, s80
    buffer_load_dwordx4 v[192:195], v22, s[20:23], s89 offen offset:0 sc1
    buffer_load_dwordx4 v[196:199], v22, s[20:23], s89 offen offset:1024 sc1
    s_bfe_u32 s89, s96, 0x40014
    s_lshl_b32 s89, s89, 11
    s_add_u32 s89, s89, s80
    buffer_load_dwordx4 v[200:203], v22, s[20:23], s89 offen offset:0 sc1
    buffer_load_dwordx4 v[204:207], v22, s[20:23], s89 offen offset:1024 sc1
    s_bfe_u32 s89, s96, 0x40018
    s_lshl_b32 s89, s89, 11
    s_add_u32 s89, s89, s80
    buffer_load_dwordx4 v[128:131], v22, s[20:23], s89 offen offset:0 sc1
    buffer_load_dwordx4 v[132:135], v22, s[20:23], s89 offen offset:1024 sc1
    s_bfe_u32 s89, s96, 0x4001c
    s_lshl_b32 s89, s89, 11
    s_add_u32 s89, s89, s80
    buffer_load_dwordx4 v[136:139], v22, s[20:23], s89 offen offset:0 sc1
    buffer_load_dwordx4 v[140:143], v22, s[20:23], s89 offen offset:1024 sc1
    s_bfe_u32 s89, s97, 0x40000
    s_lshl_b32 s89, s89, 11
    s_add_u32 s89, s89, s80
    buffer_load_dwordx4 v[208:211], v22, s[20:23], s89 offen offset:0 sc1
    buffer_load_dwordx4 v[212:215], v22, s[20:23], s89 offen offset:1024 sc1
    s_bfe_u32 s89, s97, 0x40004
    s_lshl_b32 s89, s89, 11
    s_add_u32 s89, s89, s80
    buffer_load_dwordx4 v[216:219], v22, s[20:23], s89 offen offset:0 sc1
    buffer_load_dwordx4 v[220:223], v22, s[20:23], s89 offen offset:1024 sc1
    s_bfe_u32 s89, s98, 0x80000
    s_lshl_b32 s89, s89, 11
    s_add_u32 s89, s89, s82
    buffer_load_dwordx4 v[144:147], v22, s[20:23], s89 offen offset:0 sc1
    buffer_load_dwordx4 v[148:151], v22, s[20:23], s89 offen offset:1024 sc1
    s_bfe_u32 s89, s98, 0x80008
    s_lshl_b32 s89, s89, 11
    s_add_u32 s89, s89, s82
    buffer_load_dwordx4 v[152:155], v22, s[20:23], s89 offen offset:0 sc1
    buffer_load_dwordx4 v[156:159], v22, s[20:23], s89 offen offset:1024 sc1
    s_bfe_u32 s89, s98, 0x80010
    s_lshl_b32 s89, s89, 11
    s_add_u32 s89, s89, s82
    buffer_load_dwordx4 v[224:227], v22, s[20:23], s89 offen offset:0 sc1
    s_waitcnt vmcnt(17)
    s_barrier
    s_add_u32 s61, s76, 1
    s_cmp_lg_u32 s46, 0
    s_cbranch_scc1 p2_npBc
    s_setprio 3
    s_mov_b64 exec, 1
    v_mov_b32 v20, s61
    s_lshl_b32 s3, s50, 4
    s_add_u32 s3, s3, s52
    s_lshl_b32 s3, s3, 7
    s_add_u32 s3, s3, 28672
    buffer_store_dword v20, off, s[20:23], s3 sc1
    s_mov_b64 exec, -1
    s_setprio 2
p2_npBc:
    buffer_load_dwordx4 v[228:231], v22, s[20:23], s89 offen offset:1024 sc1
    s_bfe_u32 s89, s98, 0x80018
    s_lshl_b32 s89, s89, 11
    s_add_u32 s89, s89, s82
    buffer_load_dwordx4 v[232:235], v22, s[20:23], s89 offen offset:0 sc1
    buffer_load_dwordx4 v[236:239], v22, s[20:23], s89 offen offset:1024 sc1
    s_bfe_u32 s89, s99, 0x80000
    s_lshl_b32 s89, s89, 11
    s_add_u32 s89, s89, s82
    buffer_load_dwordx4 v[160:163], v22, s[20:23], s89 offen offset:0 sc1
    buffer_load_dword v18, off, s[20:23], s87 sc1
    buffer_load_dwordx4 v[164:167], v22, s[20:23], s89 offen offset:1024 sc1
    s_bfe_u32 s89, s99, 0x80008
    s_lshl_b32 s89, s89, 11
    s_add_u32 s89, s89, s82
    buffer_load_dwordx4 v[168:171], v22, s[20:23], s89 offen offset:0 sc1
    buffer_load_dwordx4 v[172:175], v22, s[20:23], s89 offen offset:1024 sc1
    s_bfe_u32 s89, s99, 0x80010
    s_lshl_b32 s89, s89, 11
    s_add_u32 s89, s89, s82
    buffer_load_dwordx4 v[240:243], v22, s[20:23], s89 offen offset:0 sc1
    buffer_load_dwordx4 v[244:247], v22, s[20:23], s89 offen offset:1024 sc1
    s_bfe_u32 s89, s99, 0x80018
    s_lshl_b32 s89, s89, 11
    s_add_u32 s89, s89, s82
    buffer_load_dwordx4 v[248:251], v22, s[20:23], s89 offen offset:0 sc1
    buffer_load_dwordx4 v[252:255], v22, s[20:23], s89 offen offset:1024 sc1
    s_waitcnt vmcnt(7)
    s_branch p2_chk
pub:
    s_barrier
    s_add_u32 s61, s76, 1
    buffer_load_dword v18, off, s[20:23], s87 sc1
    s_waitcnt vmcnt(0)
p2_chk:
    s_add_u32 s76, s76, 1
    v_lshlrev_b32 v22, 4, v0
    v_add_u32 v21, 147456, v22
    s_mov_b32 s60, 0
    s_mov_b32 s63, s48
    s_cmp_lg_u32 s48, 0
    s_cbranch_scc1 p2_spinB
    v_cmp_eq_u32 vcc, s76, v18
    s_cbranch_vccnz p2_okB
    s_waitcnt vmcnt(0)
    s_barrier
    s_mov_b32 s63, 1
    s_cmp_lg_u32 s46, 4
    s_cbranch_scc1 p2_npA2
    s_setprio 3
    s_mov_b64 exec, 1
    v_mov_b32 v20, s76
    s_lshl_b32 s3, s50, 4
    s_add_u32 s3, s3, s52
    s_lshl_b32 s3, s3, 7
    s_add_u32 s3, s3, 28672
    buffer_store_dword v20, off, s[20:23], s3 sc1
    s_mov_b64 exec, -1
    s_setprio 0
p2_npA2:
p2_spinB:
    v_cmp_eq_u32 vcc, s76, v18
    s_cbranch_vccnz p2_okB
    s_add_u32 s60, s60, 1
    s_cmp_ge_u32 s60, 0x8000
    s_cbranch_scc1 p2_okB
    s_sleep 2
    buffer_load_dword v18, off, s[20:23], s87 sc1
    s_waitcnt vmcnt(0)
    s_branch p2_spinB
p2_okB:
    s_bfe_u32 s89, s96, 0x40000
    s_lshl_b32 s89, s89, 10
    s_add_u32 s89, s89, s84
    buffer_load_dwordx4 v[96:99], v22, s[20:23], s89 offen sc1
    buffer_load_dwordx4 v[100:103], v21, s[20:23], s89 offen sc1
    s_bfe_u32 s89, s96, 0x40004
    s_lshl_b32 s89, s89, 10
    s_add_u32 s89, s89, s84
    buffer_load_dwordx4 v[104:107], v22, s[20:23], s89 offen sc1
    buffer_load_dwordx4 v[108:111], v21, s[20:23], s89 offen sc1
    s_bfe_u32 s89, s96, 0x40008
    s_lshl_b32 s89, s89, 10
    s_add_u32 s89, s89, s84
    buffer_load_dwordx4 v[88:91], v22, s[20:23], s89 offen sc1
    buffer_load_dwordx4 v[92:95], v21, s[20:23], s89 offen sc1
    s_bfe_u32 s89, s96, 0x4000c
    s_lshl_b32 s89, s89, 10
    s_add_u32 s89, s89, s84
    buffer_load_dwordx4 v[12:15], v22, s[20:23], s89 offen sc1
    buffer_load_dwordx4 v[16:19], v21, s[20:23], s89 offen sc1
    s_bfe_u32 s89, s96, 0x40010
    s_lshl_b32 s89, s89, 10
    s_add_u32 s89, s89, s84
    buffer_load_dwordx4 v[2:5], v22, s[20:23], s89 offen sc1
    buffer_load_dwordx4 v[6:9], v21, s[20:23], s89 offen sc1
    s_cmp_lg_u32 s63, 0
    s_cbranch_scc1 p2_nopub
    s_waitcnt vmcnt(10)
    s_barrier
    s_cmp_lg_u32 s46, 4
    s_cbranch_scc1 p2_npA
    s_setprio 3
    s_mov_b64 exec, 1
    v_mov_b32 v20, s76
    s_lshl_b32 s3, s50, 4
    s_add_u32 s3, s3, s52
    s_lshl_b32 s3, s3, 7
    s_add_u32 s3, s3, 28672
    buffer_store_dword v20, off, s[20:23], s3 sc1
    s_mov_b64 exec, -1
    s_setprio 0
p2_npA:
p2_nopub:
    s_waitcnt vmcnt(8)
    v_mfma_f32_32x32x16_bf16 v[24:39], v[176:179], v[96:99], 0
    v_mfma_f32_32x32x16_bf16 v[40:55], v[180:183], v[96:99], 0
    v_mfma_f32_32x32x16_bf16 v[56:71], v[176:179], v[100:103], 0
    v_mfma_f32_32x32x16_bf16 v[72:87], v[180:183], v[100:103], 0
    buffer_load_dword v20, off, s[20:23], s88 sc1
    s_bfe_u32 s89, s96, 0x40014
    s_lshl_b32 s89, s89, 10
    s_add_u32 s89, s89, s84
    buffer_load_dwordx4 v[96:99], v22, s[20:23], s89 offen sc1
    buffer_load_dwordx4 v[100:103], v21, s[20:23], s89 offen sc1
    s_bfe_u32 s89, s96, 0x40018
    s_lshl_b32 s89, s89, 10
    s_add_u32 s89, s89, s84
    buffer_load_dwordx4 v[176:179], v22, s[20:23], s89 offen sc1
    buffer_load_dwordx4 v[180:183], v21, s[20:23], s89 offen sc1
    s_waitcnt vmcnt(11)
    v_mfma_f32_32x32x16_bf16 v[24:39], v[184:187], v[104:107], v[24:39]
    v_mfma_f32_32x32x16_bf16 v[40:55], v[188:191], v[104:107], v[40:55]
    v_mfma_f32_32x32x16_bf16 v[56:71], v[184:187], v[108:111], v[56:71]
    v_mfma_f32_32x32x16_bf16 v[72:87], v[188:191], v[108:111], v[72:87]
    s_bfe_u32 s89, s96, 0x4001c
    s_lshl_b32 s89, s89, 10
    s_add_u32 s89, s89, s84
    buffer_load_dwordx4 v[104:107], v22, s[20:23], s89 offen sc1
    buffer_load_dwordx4 v[108:111], v21, s[20:23], s89 offen sc1
    s_bfe_u32 s89, s97, 0x40000
    s_lshl_b32 s89, s89, 10
    s_add_u32 s89, s89, s84
    buffer_load_dwordx4 v[184:187], v22, s[20:23], s89 offen sc1
    buffer_load_dwordx4 v[188:191], v21, s[20:23], s89 offen sc1
    s_waitcnt vmcnt(13)
    v_mfma_f32_32x32x16_bf16 v[24:39], v[112:115], v[88:91], v[24:39]
    v_mfma_f32_32x32x16_bf16 v[40:55], v[116:119], v[88:91], v[40:55]
    v_mfma_f32_32x32x16_bf16 v[56:71], v[112:115], v[92:95], v[56:71]
    v_mfma_f32_32x32x16_bf16 v[72:87], v[116:119], v[92:95], v[72:87]
    s_bfe_u32 s89, s97, 0x40004
    s_lshl_b32 s89, s89, 10
    s_add_u32 s89, s89, s84
    buffer_load_dwordx4 v[88:91], v22, s[20:23], s89 offen sc1
    buffer_load_dwordx4 v[92:95], v21, s[20:23], s89 offen sc1
    s_waitcnt vmcnt(13)
    v_mfma_f32_32x32x16_bf16 v[24:39], v[120:123], v[12:15], v[24:39]
    v_mfma_f32_32x32x16_bf16 v[40:55], v[124:127], v[12:15], v[40:55]
    v_mfma_f32_32x32x16_bf16 v[56:71], v[120:123], v[16:19], v[56:71]
    v_mfma_f32_32x32x16_bf16 v[72:87], v[124:127], v[16:19], v[72:87]
    s_waitcnt vmcnt(11)
    v_mfma_f32_32x32x16_bf16 v[24:39], v[192:195], v[2:5], v[24:39]
    v_mfma_f32_32x32x16_bf16 v[40:55], v[196:199], v[2:5], v[40:55]
    v_mfma_f32_32x32x16_bf16 v[56:71], v[192:195], v[6:9], v[56:71]
    v_mfma_f32_32x32x16_bf16 v[72:87], v[196:199], v[6:9], v[72:87]
    s_waitcnt vmcnt(8)
    s_mov_b32 s60, 0
p2_spinA:
    v_cmp_eq_u32 vcc, s76, v20
    s_cbranch_vccnz p2_okA
    s_add_u32 s60, s60, 1
    s_cmp_ge_u32 s60, 0x8000
    s_cbranch_scc1 p2_okA
    s_sleep 2
    buffer_load_dword v20, off, s[20:23], s88 sc1
    s_waitcnt vmcnt(0)
    s_branch p2_spinA
p2_okA:
    s_bfe_u32 s89, s98, 0x80000
    s_lshl_b32 s89, s89, 10
    s_add_u32 s89, s89, s86
    buffer_load_dwordx4 v[112:115], v22, s[20:23], s89 offen sc1
    buffer_load_dwordx4 v[116:119], v21, s[20:23], s89 offen sc1
    s_bfe_u32 s89, s98, 0x80008
    s_lshl_b32 s89, s89, 10
    s_add_u32 s89, s89, s86
    buffer_load_dwordx4 v[12:15], v22, s[20:23], s89 offen sc1
    buffer_load_dwordx4 v[16:19], v21, s[20:23], s89 offen sc1
    s_bfe_u32 s89, s98, 0x80010
    s_lshl_b32 s89, s89, 10
    s_add_u32 s89, s89, s86
    buffer_load_dwordx4 v[120:123], v22, s[20:23], s89 offen sc1
    buffer_load_dwordx4 v[124:127], v21, s[20:23], s89 offen sc1
    s_bfe_u32 s89, s98, 0x80018
    s_lshl_b32 s89, s89, 10
    s_add_u32 s89, s89, s86
    buffer_load_dwordx4 v[2:5], v22, s[20:23], s89 offen sc1
    buffer_load_dwordx4 v[6:9], v21, s[20:23], s89 offen sc1
    s_bfe_u32 s89, s99, 0x80000
    s_lshl_b32 s89, s89, 10
    s_add_u32 s89, s89, s86
    buffer_load_dwordx4 v[192:195], v22, s[20:23], s89 offen sc1
    buffer_load_dwordx4 v[196:199], v21, s[20:23], s89 offen sc1
    v_mfma_f32_32x32x16_bf16 v[24:39], v[200:203], v[96:99], v[24:39]
    v_mfma_f32_32x32x16_bf16 v[40:55], v[204:207], v[96:99], v[40:55]
    v_mfma_f32_32x32x16_bf16 v[56:71], v[200:203], v[100:103], v[56:71]
    v_mfma_f32_32x32x16_bf16 v[72:87], v[204:207], v[100:103], v[72:87]
    s_bfe_u32 s89, s99, 0x80008
    s_lshl_b32 s89, s89, 10
    s_add_u32 s89, s89, s86
    buffer_load_dwordx4 v[96:99], v22, s[20:23], s89 offen sc1
    buffer_load_dwordx4 v[100:103], v21, s[20:23], s89 offen sc1
    s_bfe_u32 s89, s99, 0x80010
    s_lshl_b32 s89, s89, 10
    s_add_u32 s89, s89, s86
    buffer_load_dwordx4 v[200:203], v22, s[20:23], s89 offen sc1
    buffer_load_dwordx4 v[204:207], v21, s[20:23], s89 offen sc1
    s_waitcnt vmcnt(20)
    v_mfma_f32_32x32x16_bf16 v[24:39], v[128:131], v[176:179], v[24:39]
    v_mfma_f32_32x32x16_bf16 v[40:55], v[132:135], v[176:179], v[40:55]
    v_mfma_f32_32x32x16_bf16 v[56:71], v[128:131], v[180:183], v[56:71]
    v_mfma_f32_32x32x16_bf16 v[72:87], v[132:135], v[180:183], v[72:87]
    s_bfe_u32 s89, s99, 0x80018
    s_lshl_b32 s89, s89, 10
    s_add_u32 s89, s89, s86
    buffer_load_dwordx4 v[176:179], v22, s[20:23], s89 offen sc1
    buffer_load_dwordx4 v[180:183], v21, s[20:23], s89 offen sc1
    s_and_b32 s60, s46, 3
    s_lshl_b32 s60, s60, 3
    v_and_b32 v10, 7, v0
    v_add_u32 v10, s60, v10
    v_and_b32 v11, 15, v10
    v_lshlrev_b32 v11, 1, v11
    v_lshrrev_b32 v1, 4, v10
    v_add_u32 v11, v11, v1
    s_lshr_b32 s61, s46, 2
    s_lshl_b32 s61, s61, 5
    s_lshl_b32 s62, s78, 6
    s_add_u32 s61, s61, s62
    v_add_u32 v11, s61, v11
    v_lshlrev_b32 v11, 10, v11
    v_bfe_u32 v1, v0, 3, 2
    v_lshlrev_b32 v1, 5, v1
    v_add_u32 v11, v11, v1
    v_lshrrev_b32 v1, 5, v0
    v_lshlrev_b32 v1, 4, v1
    v_add_u32 v11, v11, v1
    s_lshl_b32 s62, s77, 7
    v_add_u32 v11, s62, v11
    buffer_load_dwordx4 v[128:131], v11, s[4:7], 0 offen
    v_lshlrev_b32 v10, 4, v10
    v_lshrrev_b32 v1, 5, v0
    v_mul_u32_u24 v1, 81920, v1
    v_add_u32 v10, v10, v1
    v_bfe_u32 v1, v0, 4, 1
    v_mul_u32_u24 v1, 1280, v1
    v_add_u32 v10, v10, v1
    v_bfe_u32 v1, v0, 3, 1
    v_mul_u32_u24 v1, 640, v1
    v_add_u32 v10, v10, v1
    s_lshr_b32 s61, s46, 2
    s_mul_i32 s61, s61, 10240
    v_add_u32 v10, s61, v10
    v_and_b32 v20, 31, v0
    v_lshlrev_b32 v20, 4, v20
    v_lshrrev_b32 v1, 5, v0
    v_mul_u32_u24 v1, 640, v1
    v_add_u32 v20, v20, v1
    s_mul_i32 s61, s46, 20480
    v_add_u32 v20, s61, v20
    s_waitcnt vmcnt(21)
    v_mfma_f32_32x32x16_bf16 v[24:39], v[136:139], v[104:107], v[24:39]
    v_mfma_f32_32x32x16_bf16 v[40:55], v[140:143], v[104:107], v[40:55]
    v_mfma_f32_32x32x16_bf16 v[56:71], v[136:139], v[108:111], v[56:71]
    v_mfma_f32_32x32x16_bf16 v[72:87], v[140:143], v[108:111], v[72:87]
    s_waitcnt vmcnt(19)
    v_mfma_f32_32x32x16_bf16 v[24:39], v[208:211], v[184:187], v[24:39]
    v_mfma_f32_32x32x16_bf16 v[40:55], v[212:215], v[184:187], v[40:55]
    v_mfma_f32_32x32x16_bf16 v[56:71], v[208:211], v[188:191], v[56:71]
    v_mfma_f32_32x32x16_bf16 v[72:87], v[212:215], v[188:191], v[72:87]
    s_waitcnt vmcnt(17)
    v_mfma_f32_32x32x16_bf16 v[24:39], v[216:219], v[88:91], v[24:39]
    v_mfma_f32_32x32x16_bf16 v[40:55], v[220:223], v[88:91], v[40:55]
    v_mfma_f32_32x32x16_bf16 v[56:71], v[216:219], v[92:95], v[56:71]
    v_mfma_f32_32x32x16_bf16 v[72:87], v[220:223], v[92:95], v[72:87]
    s_waitcnt vmcnt(15)
    v_mfma_f32_32x32x16_bf16 v[24:39], v[144:147], v[112:115], v[24:39]
    v_mfma_f32_32x32x16_bf16 v[40:55], v[148:151], v[112:115], v[40:55]
    v_mfma_f32_32x32x16_bf16 v[56:71], v[144:147], v[116:119], v[56:71]
    v_mfma_f32_32x32x16_bf16 v[72:87], v[148:151], v[116:119], v[72:87]
    s_waitcnt vmcnt(13)
    v_mfma_f32_32x32x16_bf16 v[24:39], v[152:155], v[12:15], v[24:39]
    v_mfma_f32_32x32x16_bf16 v[40:55], v[156:159], v[12:15], v[40:55]
    v_mfma_f32_32x32x16_bf16 v[56:71], v[152:155], v[16:19], v[56:71]
    v_mfma_f32_32x32x16_bf16 v[72:87], v[156:159], v[16:19], v[72:87]
    s_waitcnt vmcnt(11)
    v_mfma_f32_32x32x16_bf16 v[24:39], v[224:227], v[120:123], v[24:39]
    v_mfma_f32_32x32x16_bf16 v[40:55], v[228:231], v[120:123], v[40:55]
    v_mfma_f32_32x32x16_bf16 v[56:71], v[224:227], v[124:127], v[56:71]
    v_mfma_f32_32x32x16_bf16 v[72:87], v[228:231], v[124:127], v[72:87]
    s_waitcnt vmcnt(9)
    v_mfma_f32_32x32x16_bf16 v[24:39], v[232:235], v[2:5], v[24:39]
    v_mfma_f32_32x32x16_bf16 v[40:55], v[236:239], v[2:5], v[40:55]
    v_mfma_f32_32x32x16_bf16 v[56:71], v[232:235], v[6:9], v[56:71]
    v_mfma_f32_32x32x16_bf16 v[72:87], v[236:239], v[6:9], v[72:87]
    s_waitcnt vmcnt(7)
    v_mfma_f32_32x32x16_bf16 v[24:39], v[160:163], v[192:195], v[24:39]
    v_mfma_f32_32x32x16_bf16 v[40:55], v[164:167], v[192:195], v[40:55]
    v_mfma_f32_32x32x16_bf16 v[56:71], v[160:163], v[196:199], v[56:71]
    v_mfma_f32_32x32x16_bf16 v[72:87], v[164:167], v[196:199], v[72:87]
    s_waitcnt vmcnt(5)
    v_mfma_f32_32x32x16_bf16 v[24:39], v[168:171], v[96:99], v[24:39]
    v_mfma_f32_32x32x16_bf16 v[40:55], v[172:175], v[96:99], v[40:55]
    v_mfma_f32_32x32x16_bf16 v[56:71], v[168:171], v[100:103], v[56:71]
    v_mfma_f32_32x32x16_bf16 v[72:87], v[172:175], v[100:103], v[72:87]
    s_waitcnt vmcnt(3)
    v_mfma_f32_32x32x16_bf16 v[24:39], v[240:243], v[200:203], v[24:39]
    v_mfma_f32_32x32x16_bf16 v[40:55], v[244:247], v[200:203], v[40:55]
    v_mfma_f32_32x32x16_bf16 v[56:71], v[240:243], v[204:207], v[56:71]
    v_mfma_f32_32x32x16_bf16 v[72:87], v[244:247], v[204:207], v[72:87]
    s_waitcnt vmcnt(1)
    v_mfma_f32_32x32x16_bf16 v[24:39], v[248:251], v[176:179], v[24:39]
    v_mfma_f32_32x32x16_bf16 v[40:55], v[252:255], v[176:179], v[40:55]
    v_mfma_f32_32x32x16_bf16 v[56:71], v[248:251], v[180:183], v[56:71]
    v_mfma_f32_32x32x16_bf16 v[72:87], v[252:255], v[180:183], v[72:87]
    s_nop 8
    ds_write_b128 v20, v[24:27] offset:0
    ds_write_b128 v20, v[28:31] offset:1280
    ds_write_b128 v20, v[32:35] offset:2560
    ds_write_b128 v20, v[36:39] offset:3840
    ds_write_b128 v20, v[40:43] offset:5120
    ds_write_b128 v20, v[44:47] offset:6400
    ds_write_b128 v20, v[48:51] offset:7680
    ds_write_b128 v20, v[52:55] offset:8960
    ds_write_b128 v20, v[56:59] offset:10240
    ds_write_b128 v20, v[60:63] offset:11520
    ds_write_b128 v20, v[64:67] offset:12800
    ds_write_b128 v20, v[68:71] offset:14080
    ds_write_b128 v20, v[72:75] offset:15360
    ds_write_b128 v20, v[76:79] offset:16640
    ds_write_b128 v20, v[80:83] offset:17920
    ds_write_b128 v20, v[84:87] offset:19200
    s_waitcnt vmcnt(0)
    s_waitcnt lgkmcnt(0)
    v_lshlrev_b32 v24, 16, v128
    v_and_b32 v25, 0xffff0000, v128
    v_lshlrev_b32 v26, 16, v129
    v_and_b32 v27, 0xffff0000, v129
    v_lshlrev_b32 v28, 16, v130
    v_and_b32 v29, 0xffff0000, v130
    v_lshlrev_b32 v30, 16, v131
    v_and_b32 v31, 0xffff0000, v131
    s_barrier
    v_add_u32 v1, 40960, v10
    ds_read_b128 v[96:99], v10 offset:0
    ds_read_b128 v[100:103], v10 offset:2560
    ds_read_b128 v[104:107], v10 offset:5120
    ds_read_b128 v[108:111], v10 offset:7680
    ds_read_b128 v[112:115], v10 offset:20480
    ds_read_b128 v[116:119], v10 offset:23040
    ds_read_b128 v[120:123], v10 offset:25600
    ds_read_b128 v[124:127], v10 offset:28160
    ds_read_b128 v[128:131], v1 offset:0
    ds_read_b128 v[132:135], v1 offset:2560
    ds_read_b128 v[136:139], v1 offset:5120
    ds_read_b128 v[140:143], v1 offset:7680
    ds_read_b128 v[144:147], v1 offset:20480
    ds_read_b128 v[148:151], v1 offset:23040
    ds_read_b128 v[152:155], v1 offset:25600
    ds_read_b128 v[156:159], v1 offset:28160
    s_waitcnt lgkmcnt(8)
    v_pk_add_f32 v[96:97], v[96:97], v[112:113]
    v_pk_add_f32 v[98:99], v[98:99], v[114:115]
    v_pk_add_f32 v[100:101], v[100:101], v[116:117]
    v_pk_add_f32 v[102:103], v[102:103], v[118:119]
    v_pk_add_f32 v[104:105], v[104:105], v[120:121]
    v_pk_add_f32 v[106:107], v[106:107], v[122:123]
    v_pk_add_f32 v[108:109], v[108:109], v[124:125]
    v_pk_add_f32 v[110:111], v[110:111], v[126:127]
    s_waitcnt lgkmcnt(0)
    v_pk_add_f32 v[128:129], v[128:129], v[144:145]
    v_pk_add_f32 v[130:131], v[130:131], v[146:147]
    v_pk_add_f32 v[132:133], v[132:133], v[148:149]
    v_pk_add_f32 v[134:135], v[134:135], v[150:151]
    v_pk_add_f32 v[136:137], v[136:137], v[152:153]
    v_pk_add_f32 v[138:139], v[138:139], v[154:155]
    v_pk_add_f32 v[140:141], v[140:141], v[156:157]
    v_pk_add_f32 v[142:143], v[142:143], v[158:159]
    v_pk_add_f32 v[96:97], v[96:97], v[128:129]
    v_pk_add_f32 v[98:99], v[98:99], v[130:131]
    v_pk_add_f32 v[100:101], v[100:101], v[132:133]
    v_pk_add_f32 v[102:103], v[102:103], v[134:135]
    v_pk_add_f32 v[104:105], v[104:105], v[136:137]
    v_pk_add_f32 v[106:107], v[106:107], v[138:139]
    v_pk_add_f32 v[108:109], v[108:109], v[140:141]
    v_pk_add_f32 v[110:111], v[110:111], v[142:143]
    v_permlane32_swap_b32 v96, v98
    v_permlane32_swap_b32 v97, v99
    v_permlane32_swap_b32 v100, v102
    v_permlane32_swap_b32 v101, v103
    v_permlane32_swap_b32 v104, v106
    v_permlane32_swap_b32 v105, v107
    v_permlane32_swap_b32 v108, v110
    v_permlane32_swap_b32 v109, v111
    v_add_f32 v96, v96, v98
    v_add_f32 v100, v100, v102
    v_add_f32 v104, v104, v106
    v_add_f32 v108, v108, v110
    v_add_f32 v97, v97, v99
    v_add_f32 v101, v101, v103
    v_add_f32 v105, v105, v107
    v_add_f32 v109, v109, v111
    v_add_f32 v24, v24, v96
    v_add_f32 v25, v25, v100
    v_add_f32 v26, v26, v104
    v_add_f32 v27, v27, v108
    v_add_f32 v28, v28, v97
    v_add_f32 v29, v29, v101
    v_add_f32 v30, v30, v105
    v_add_f32 v31, v31, v109
    v_cvt_pk_bf16_f32 v32, v24, v25
    v_cvt_pk_bf16_f32 v33, v26, v27
    v_cvt_pk_bf16_f32 v34, v28, v29
    v_cvt_pk_bf16_f32 v35, v30, v31
    buffer_store_dwordx4 v[32:35], v11, s[36:39], 0 offen sc1
    s_or_b32 s3, s2, s46
    s_cmp_lg_u32 s3, 0
    s_cbranch_scc1 p2_noep
    s_mov_b64 exec, 1
    v_mov_b32 v20, s76
    s_mov_b32 s3, 16384
    buffer_store_dword v20, off, s[20:23], s3
    s_mov_b64 exec, -1
p2_noep:
p1_done:
    s_waitcnt vmcnt(0)
k1_done:
    s_endpgm
.section .rodata,"a"
.p2align 6
.amdhsa_kernel parallel_sum__sliding_local_dilated__glu_gated_bilinear__prompt_kernel
  .amdhsa_next_free_vgpr 256
  .amdhsa_next_free_sgpr 102
  .amdhsa_accum_offset 256
  .amdhsa_group_segment_fixed_size 0
  .amdhsa_kernarg_size 80
  .amdhsa_user_sgpr_count 2
  .amdhsa_user_sgpr_kernarg_segment_ptr 1
  .amdhsa_system_sgpr_workgroup_id_x 1
.end_amdhsa_kernel
```
